```python
import torch

def _softmax(x, axis=-1):
    return torch.softmax(x, dim=axis)
def _gelu(x):
    return torch.nn.functional.gelu(x, approximate="tanh")
def _silu(x):
    return torch.nn.functional.silu(x)
def _sigmoid(x):
    return torch.sigmoid(x)
def _layernorm(x, axis=-1, eps=1e-5):
    m = x.mean(dim=axis, keepdim=True)
    v = x.var(dim=axis, keepdim=True, unbiased=False)
    return (x - m) / torch.sqrt(v + eps)
def _scatter_add(tgt, idx, src, axis=0):
    return tgt.clone().index_add_(axis, idx, src)
def _segment_sum(src, seg, n):
    out = torch.zeros((n,) + src.shape[1:], dtype=src.dtype)
    return out.index_add_(0, seg, src)
def _pad(x, pw):
    flat = tuple(v for pair in reversed(pw) for v in pair)
    return torch.nn.functional.pad(x, flat)

kernel_name = 'concat_heads__gqa_block_cached__mha_block_cached__near_ridge'

def setup_inputs():

    _w = (lambda a: (lambda t: t.to(torch.bfloat16) if t.is_floating_point() else t)(torch.as_tensor(a)))
    def _A_setup():
        B, Sq, D = 8, 48, 1024
        Hq, Hkv, Sk, Dh = 32, 4, 2048, 128
        assert Hq % Hkv == 0, (Hq, Hkv)
        return {
            "x": _w((lambda *s: torch.randn(*s, dtype=torch.bfloat16) * 0.8)(B, Sq, D)),
            "k_cache": _w((lambda *s: torch.randn(*s, dtype=torch.bfloat16) * 0.8)(B, Hkv, Sk, Dh)),
            "v_cache": _w((lambda *s: torch.randn(*s, dtype=torch.bfloat16) * 0.05)(B, Hkv, Sk, Dh)),
            "wq": _w((lambda *s: torch.randn(*s, dtype=torch.bfloat16) * 0.8)(D, Hq * Dh) * (D ** -0.5)),
            "wo": _w((lambda *s: torch.randn(*s, dtype=torch.bfloat16) * 0.05)(Hq * Dh, D) * ((Hq * Dh) ** -0.5)),
        }
    _A_in = _A_setup()

    def _B_setup():
        B, Sq, D = 8, 48, 1024
        H, Sk, Dh = 32, 2048, 128
        return {
            "x": _w((lambda *s: torch.randn(*s, dtype=torch.bfloat16) * 0.8)(B, Sq, D)),
            "k_cache": _w((lambda *s: torch.randn(*s, dtype=torch.bfloat16) * 0.8)(B, H, Sk, Dh)),
            "v_cache": _w((lambda *s: torch.randn(*s, dtype=torch.bfloat16) * 0.05)(B, H, Sk, Dh)),
            "wq": _w((lambda *s: torch.randn(*s, dtype=torch.bfloat16) * 0.8)(D, H * Dh) * (D ** -0.5)),
            "wo": _w((lambda *s: torch.randn(*s, dtype=torch.bfloat16) * 0.05)(H * Dh, D) * ((H * Dh) ** -0.5)),
        }
    _B_in = _B_setup()

    return {
        "A_x": _A_in["x"],
        "A_k_cache": _A_in["k_cache"],
        "A_v_cache": _A_in["v_cache"],
        "A_wq": _A_in["wq"],
        "A_wo": _A_in["wo"],
        "B_x": _B_in["x"],
        "B_k_cache": _B_in["k_cache"],
        "B_v_cache": _B_in["v_cache"],
        "B_wq": _B_in["wq"],
        "B_wo": _B_in["wo"],
    }

def reference(A_x, A_k_cache, A_v_cache, A_wq, A_wo, B_x, B_k_cache, B_v_cache, B_wq, B_wo):
    def _A_ref(x, k_cache, v_cache, wq, wo):
        B, Sq, D = x.shape
        Hq, Dh = 32, 128
        Hkv = k_cache.shape[1]
        rep = Hq // Hkv
        q = (lambda x, *d: x.permute(*d))((x @ wq).reshape(B, Sq, Hq, Dh), 0, 2, 1, 3)
        k = (lambda x, n, axis: torch.repeat_interleave(x, n, dim=axis))(k_cache, rep, axis=1)
        v = (lambda x, n, axis: torch.repeat_interleave(x, n, dim=axis))(v_cache, rep, axis=1)
        scores = torch.einsum("bhqd,bhkd->bhqk", q, k) * (Dh ** -0.5)
        p = _softmax(scores, axis=-1)
        o = torch.einsum("bhqk,bhkd->bhqd", p, v)
        return (lambda x, *d: x.permute(*d))(o, 0, 2, 1, 3).reshape(B, Sq, Hq * Dh) @ wo

    def _B_ref(x, k_cache, v_cache, wq, wo):
        B, Sq, D = x.shape
        H, Dh = 32, 128
        q = (lambda x, *d: x.permute(*d))((x @ wq).reshape(B, Sq, H, Dh), 0, 2, 1, 3)
        scores = torch.einsum("bhqd,bhkd->bhqk", q, k_cache) * (Dh ** -0.5)
        p = _softmax(scores, axis=-1)
        o = torch.einsum("bhqk,bhkd->bhqd", p, v_cache)
        return (lambda x, *d: x.permute(*d))(o, 0, 2, 1, 3).reshape(B, Sq, H * Dh) @ wo

    a = _A_ref(A_x, A_k_cache, A_v_cache, A_wq, A_wo)
    b = _B_ref(B_x, B_k_cache, B_v_cache, B_wq, B_wo)
    return torch.concatenate([a, b], axis=-1)
```

```asm
; @launch grid=(256,1,1) block=(512,1,1) lds=163840
.amdgcn_target "amdgcn-amd-amdhsa--gfx950"
.text
.globl concat_heads__gqa_block_cached__mha_block_cached__near_ridge_kernel
.p2align 8
.type concat_heads__gqa_block_cached__mha_block_cached__near_ridge_kernel,@function
concat_heads__gqa_block_cached__mha_block_cached__near_ridge_kernel:
  s_cmp_ge_u32 s2, 256
  s_cbranch_scc1 L_end
  s_load_dwordx16 s[36:51], s[0:1], 0
  s_load_dwordx8 s[52:59], s[0:1], 64
  s_load_dwordx2 s[60:61], s[0:1], 96
  v_lshrrev_b32 v1, 6, v0
  v_and_b32 v0, 63, v0
  v_mov_b32 v2, 0
  v_readfirstlane_b32 s3, v1
  s_and_b32 s62, s2, 7
  s_bfe_u32 s64, s2, 0x10003
  s_lshr_b32 s63, s2, 4
  s_lshr_b32 s35, s3, 2
  s_lshr_b32 s22, s63, 2
  s_and_b32 s23, s63, 3
  s_lshl_b32 s20, s22, 3
  s_add_u32 s20, s20, s62
  s_lshl_b32 s20, s20, 2
  s_add_u32 s65, s20, s23
  s_cmp_eq_u32 s64, 0
  s_cbranch_scc0 L_ypart
  s_cmp_eq_u32 s35, 0
  s_cbranch_scc1 L_b_comp
  v_lshrrev_b32 v5, 4, v0
  v_and_b32 v6, 15, v0
  v_lshlrev_b32 v7, 1, v5
  v_xor_b32 v7, v7, v6
  v_lshlrev_b32 v7, 4, v7
  v_lshl_add_u32 v3, v5, 8, v7
  v_xor_b32 v4, 128, v3
  s_and_b32 s25, s3, 3
  s_lshl_b32 s25, s25, 13
  s_and_b32 s24, s3, 1
  s_lshl_b32 s24, s24, 15
  s_bfe_u32 s20, s3, 0x10001
  s_lshl_b32 s20, s20, 16
  s_or_b32 s24, s24, s20
  s_and_b32 s23, s3, 1
  s_lshl_b32 s23, s23, 15
  s_bfe_u32 s20, s3, 0x10001
  s_lshl_b32 s20, s20, 16
  s_or_b32 s23, s23, s20
  v_and_b32 v3, 0xff, v3
  v_bfe_u32 v5, v0, 4, 1
  v_lshl_add_u32 v3, v5, 8, v3
  v_lshrrev_b32 v5, 5, v0
  v_lshl_add_u32 v3, v5, 11, v3
  v_xor_b32 v4, 128, v3
  s_lshl_b32 s21, s65, 19
  s_waitcnt lgkmcnt(0)
  s_add_u32 s72, s48, s21
  s_addc_u32 s73, s49, 0
  s_mov_b32 s74, 67633152
  s_mov_b32 s75, 0x20000
  s_mov_b32 s22, 0
  s_mov_b32 s87, 32768
  s_call_b64 s[88:89], F_ldk0
  s_branch L_l_go
F_ldk0:
  s_xor_b32 s20, s24, s22
  s_add_u32 m0, s25, s87
  s_waitcnt vmcnt(15)
  buffer_load_dwordx4 v3, s[72:75], s20 offen nt lds
  s_add_u32 m0, m0, 1024
  s_xor_b32 s20, s20, 4096
  s_waitcnt vmcnt(15)
  buffer_load_dwordx4 v3, s[72:75], s20 offen nt lds
  s_add_u32 m0, m0, 1024
  s_xor_b32 s20, s20, 12288
  s_waitcnt vmcnt(15)
  buffer_load_dwordx4 v4, s[72:75], s20 offen nt lds
  s_add_u32 m0, m0, 1024
  s_xor_b32 s20, s20, 4096
  s_waitcnt vmcnt(15)
  buffer_load_dwordx4 v4, s[72:75], s20 offen nt lds
  s_add_u32 m0, m0, 1024
  s_xor_b32 s20, s20, 28672
  s_waitcnt vmcnt(15)
  buffer_load_dwordx4 v3, s[72:75], s20 offen nt lds
  s_add_u32 m0, m0, 1024
  s_xor_b32 s20, s20, 4096
  s_waitcnt vmcnt(15)
  buffer_load_dwordx4 v3, s[72:75], s20 offen nt lds
  s_add_u32 m0, m0, 1024
  s_xor_b32 s20, s20, 12288
  s_waitcnt vmcnt(15)
  buffer_load_dwordx4 v4, s[72:75], s20 offen nt lds
  s_add_u32 m0, m0, 1024
  s_xor_b32 s20, s20, 4096
  s_waitcnt vmcnt(15)
  buffer_load_dwordx4 v4, s[72:75], s20 offen nt lds
  s_setpc_b64 s[88:89]
F_ldv0:
  s_xor_b32 s20, s24, s22
  s_add_u32 m0, s25, s87
  s_waitcnt vmcnt(15)
  buffer_load_dwordx4 v3, s[76:79], s20 offen nt lds
  s_add_u32 m0, m0, 1024
  s_xor_b32 s20, s20, 4096
  s_waitcnt vmcnt(15)
  buffer_load_dwordx4 v3, s[76:79], s20 offen nt lds
  s_add_u32 m0, m0, 1024
  s_xor_b32 s20, s20, 12288
  s_waitcnt vmcnt(15)
  buffer_load_dwordx4 v4, s[76:79], s20 offen nt lds
  s_add_u32 m0, m0, 1024
  s_xor_b32 s20, s20, 4096
  s_waitcnt vmcnt(15)
  buffer_load_dwordx4 v4, s[76:79], s20 offen nt lds
  s_add_u32 m0, m0, 1024
  s_xor_b32 s20, s20, 28672
  s_waitcnt vmcnt(15)
  buffer_load_dwordx4 v3, s[76:79], s20 offen nt lds
  s_add_u32 m0, m0, 1024
  s_xor_b32 s20, s20, 4096
  s_waitcnt vmcnt(15)
  buffer_load_dwordx4 v3, s[76:79], s20 offen nt lds
  s_add_u32 m0, m0, 1024
  s_xor_b32 s20, s20, 12288
  s_waitcnt vmcnt(15)
  buffer_load_dwordx4 v4, s[76:79], s20 offen nt lds
  s_add_u32 m0, m0, 1024
  s_xor_b32 s20, s20, 4096
  s_waitcnt vmcnt(15)
  buffer_load_dwordx4 v4, s[76:79], s20 offen nt lds
  s_setpc_b64 s[88:89]
L_l_go:
  s_add_u32 s76, s50, s21
  s_addc_u32 s77, s51, 0
  s_mov_b32 s78, 67633152
  s_mov_b32 s79, 0x20000
  s_mov_b32 s22, 0
  s_mov_b32 s87, 65536
  s_call_b64 s[88:89], F_ldv0
  s_mov_b32 s22, 512
  s_mov_b32 s87, 98304
  s_call_b64 s[88:89], F_ldk0
  s_mov_b32 s22, 512
  s_mov_b32 s87, 131072
  s_call_b64 s[88:89], F_ldv0
  s_xor_b32 s20, s23, 67109888
  s_waitcnt vmcnt(15)
  buffer_load_dwordx4 v[20:23], v3, s[72:75], s20 offen nt
  s_xor_b32 s20, s20, 4096
  s_waitcnt vmcnt(15)
  buffer_load_dwordx4 v[24:27], v3, s[72:75], s20 offen nt
  s_xor_b32 s20, s20, 12288
  s_waitcnt vmcnt(15)
  buffer_load_dwordx4 v[28:31], v4, s[72:75], s20 offen nt
  s_xor_b32 s20, s20, 4096
  s_waitcnt vmcnt(15)
  buffer_load_dwordx4 v[32:35], v4, s[72:75], s20 offen nt
  s_xor_b32 s20, s20, 28672
  s_waitcnt vmcnt(15)
  buffer_load_dwordx4 v[36:39], v3, s[72:75], s20 offen nt
  s_xor_b32 s20, s20, 4096
  s_waitcnt vmcnt(15)
  buffer_load_dwordx4 v[40:43], v3, s[72:75], s20 offen nt
  s_xor_b32 s20, s20, 12288
  s_waitcnt vmcnt(15)
  buffer_load_dwordx4 v[44:47], v4, s[72:75], s20 offen nt
  s_xor_b32 s20, s20, 4096
  s_waitcnt vmcnt(15)
  buffer_load_dwordx4 v[48:51], v4, s[72:75], s20 offen nt
  s_waitcnt vmcnt(24)
  s_barrier
  s_xor_b32 s20, s23, 67239936
  s_waitcnt vmcnt(15)
  buffer_load_dwordx4 v[52:55], v3, s[72:75], s20 offen nt
  s_xor_b32 s20, s20, 4096
  s_waitcnt vmcnt(15)
  buffer_load_dwordx4 v[56:59], v3, s[72:75], s20 offen nt
  s_xor_b32 s20, s20, 12288
  s_waitcnt vmcnt(15)
  buffer_load_dwordx4 v[60:63], v4, s[72:75], s20 offen nt
  s_xor_b32 s20, s20, 4096
  s_waitcnt vmcnt(15)
  buffer_load_dwordx4 v[64:67], v4, s[72:75], s20 offen nt
  s_xor_b32 s20, s20, 28672
  s_waitcnt vmcnt(15)
  buffer_load_dwordx4 v[68:71], v3, s[72:75], s20 offen nt
  s_xor_b32 s20, s20, 4096
  s_waitcnt vmcnt(15)
  buffer_load_dwordx4 v[72:75], v3, s[72:75], s20 offen nt
  s_xor_b32 s20, s20, 12288
  s_waitcnt vmcnt(15)
  buffer_load_dwordx4 v[76:79], v4, s[72:75], s20 offen nt
  s_xor_b32 s20, s20, 4096
  s_waitcnt vmcnt(15)
  buffer_load_dwordx4 v[80:83], v4, s[72:75], s20 offen nt
  s_barrier
  s_xor_b32 s20, s23, 67240960
  s_waitcnt vmcnt(15)
  buffer_load_dwordx4 v[84:87], v3, s[72:75], s20 offen nt
  s_xor_b32 s20, s20, 4096
  s_waitcnt vmcnt(15)
  buffer_load_dwordx4 v[88:91], v3, s[72:75], s20 offen nt
  s_xor_b32 s20, s20, 12288
  s_waitcnt vmcnt(15)
  buffer_load_dwordx4 v[92:95], v4, s[72:75], s20 offen nt
  s_xor_b32 s20, s20, 4096
  s_waitcnt vmcnt(15)
  buffer_load_dwordx4 v[96:99], v4, s[72:75], s20 offen nt
  s_xor_b32 s20, s20, 28672
  s_waitcnt vmcnt(15)
  buffer_load_dwordx4 v[100:103], v3, s[72:75], s20 offen nt
  s_xor_b32 s20, s20, 4096
  s_waitcnt vmcnt(15)
  buffer_load_dwordx4 v[104:107], v3, s[72:75], s20 offen nt
  s_xor_b32 s20, s20, 12288
  s_waitcnt vmcnt(15)
  buffer_load_dwordx4 v[108:111], v4, s[72:75], s20 offen nt
  s_xor_b32 s20, s20, 4096
  s_waitcnt vmcnt(15)
  buffer_load_dwordx4 v[112:115], v4, s[72:75], s20 offen nt
  s_xor_b32 s20, s23, 67241472
  s_waitcnt vmcnt(15)
  buffer_load_dwordx4 v[116:119], v3, s[76:79], s20 offen nt
  s_xor_b32 s20, s20, 4096
  s_waitcnt vmcnt(15)
  buffer_load_dwordx4 v[120:123], v3, s[76:79], s20 offen nt
  s_xor_b32 s20, s20, 12288
  s_waitcnt vmcnt(15)
  buffer_load_dwordx4 v[124:127], v4, s[76:79], s20 offen nt
  s_xor_b32 s20, s20, 4096
  s_waitcnt vmcnt(15)
  buffer_load_dwordx4 v[128:131], v4, s[76:79], s20 offen nt
  s_xor_b32 s20, s20, 28672
  s_waitcnt vmcnt(15)
  buffer_load_dwordx4 v[132:135], v3, s[76:79], s20 offen nt
  s_xor_b32 s20, s20, 4096
  s_waitcnt vmcnt(15)
  buffer_load_dwordx4 v[136:139], v3, s[76:79], s20 offen nt
  s_xor_b32 s20, s20, 12288
  s_waitcnt vmcnt(15)
  buffer_load_dwordx4 v[140:143], v4, s[76:79], s20 offen nt
  s_xor_b32 s20, s20, 4096
  s_waitcnt vmcnt(15)
  buffer_load_dwordx4 v[144:147], v4, s[76:79], s20 offen nt
  s_xor_b32 s20, s23, 67371520
  s_waitcnt vmcnt(15)
  buffer_load_dwordx4 v[148:151], v3, s[72:75], s20 offen nt
  s_xor_b32 s20, s20, 4096
  s_waitcnt vmcnt(15)
  buffer_load_dwordx4 v[152:155], v3, s[72:75], s20 offen nt
  s_xor_b32 s20, s20, 12288
  s_waitcnt vmcnt(15)
  buffer_load_dwordx4 v[156:159], v4, s[72:75], s20 offen nt
  s_xor_b32 s20, s20, 4096
  s_waitcnt vmcnt(15)
  buffer_load_dwordx4 v[160:163], v4, s[72:75], s20 offen nt
  s_xor_b32 s20, s20, 28672
  s_waitcnt vmcnt(15)
  buffer_load_dwordx4 v[164:167], v3, s[72:75], s20 offen nt
  s_xor_b32 s20, s20, 4096
  s_waitcnt vmcnt(15)
  buffer_load_dwordx4 v[168:171], v3, s[72:75], s20 offen nt
  s_xor_b32 s20, s20, 12288
  s_waitcnt vmcnt(15)
  buffer_load_dwordx4 v[172:175], v4, s[72:75], s20 offen nt
  s_xor_b32 s20, s20, 4096
  s_waitcnt vmcnt(15)
  buffer_load_dwordx4 v[176:179], v4, s[72:75], s20 offen nt
  s_xor_b32 s20, s23, 67372032
  s_waitcnt vmcnt(15)
  buffer_load_dwordx4 v[180:183], v3, s[76:79], s20 offen nt
  s_xor_b32 s20, s20, 4096
  s_waitcnt vmcnt(15)
  buffer_load_dwordx4 v[184:187], v3, s[76:79], s20 offen nt
  s_xor_b32 s20, s20, 12288
  s_waitcnt vmcnt(15)
  buffer_load_dwordx4 v[188:191], v4, s[76:79], s20 offen nt
  s_xor_b32 s20, s20, 4096
  s_waitcnt vmcnt(15)
  buffer_load_dwordx4 v[192:195], v4, s[76:79], s20 offen nt
  s_xor_b32 s20, s20, 28672
  s_waitcnt vmcnt(15)
  buffer_load_dwordx4 v[196:199], v3, s[76:79], s20 offen nt
  s_xor_b32 s20, s20, 4096
  s_waitcnt vmcnt(15)
  buffer_load_dwordx4 v[200:203], v3, s[76:79], s20 offen nt
  s_xor_b32 s20, s20, 12288
  s_waitcnt vmcnt(15)
  buffer_load_dwordx4 v[204:207], v4, s[76:79], s20 offen nt
  s_xor_b32 s20, s20, 4096
  s_waitcnt vmcnt(15)
  buffer_load_dwordx4 v[208:211], v4, s[76:79], s20 offen nt
  s_xor_b32 s20, s23, 67502080
  s_waitcnt vmcnt(15)
  buffer_load_dwordx4 v[212:215], v3, s[72:75], s20 offen nt
  s_xor_b32 s20, s20, 4096
  s_waitcnt vmcnt(15)
  buffer_load_dwordx4 v[216:219], v3, s[72:75], s20 offen nt
  s_xor_b32 s20, s20, 12288
  s_waitcnt vmcnt(15)
  buffer_load_dwordx4 v[220:223], v4, s[72:75], s20 offen nt
  s_xor_b32 s20, s20, 4096
  s_waitcnt vmcnt(15)
  buffer_load_dwordx4 v[224:227], v4, s[72:75], s20 offen nt
  s_xor_b32 s20, s20, 28672
  s_waitcnt vmcnt(15)
  buffer_load_dwordx4 v[228:231], v3, s[72:75], s20 offen nt
  s_xor_b32 s20, s20, 4096
  s_waitcnt vmcnt(15)
  buffer_load_dwordx4 v[232:235], v3, s[72:75], s20 offen nt
  s_xor_b32 s20, s20, 12288
  s_waitcnt vmcnt(15)
  buffer_load_dwordx4 v[236:239], v4, s[72:75], s20 offen nt
  s_xor_b32 s20, s20, 4096
  s_waitcnt vmcnt(15)
  buffer_load_dwordx4 v[240:243], v4, s[72:75], s20 offen nt
  s_mov_b32 s22, 1024
  s_mov_b32 s87, 32768
  s_call_b64 s[88:89], F_ldv0
  s_mov_b32 s22, 1536
  s_mov_b32 s87, 65536
  s_call_b64 s[88:89], F_ldk0
  v_lshlrev_b32 v1, 4, v0
  v_add_u32 v2, s25, v1
  s_and_b32 s20, s3, 3
  s_mul_i32 s20, s20, 3072
  v_add_u32 v1, s20, v1
  s_barrier
  ds_read_b128 v[8:11], v1 offset:16384
  ds_read_b128 v[12:15], v1 offset:17408
  ds_read_b128 v[16:19], v1 offset:18432
  s_waitcnt lgkmcnt(0)
  s_waitcnt vmcnt(63)
  s_barrier
  s_mov_b32 s22, 1024
  s_mov_b32 s87, 0
  s_call_b64 s[88:89], F_ldk0
  s_waitcnt vmcnt(63)
  s_barrier
  s_waitcnt vmcnt(63)
  s_barrier
  s_waitcnt vmcnt(63)
  s_barrier
  s_mov_b32 s22, 1536
  s_mov_b32 s87, 98304
  s_call_b64 s[88:89], F_ldv0
  s_waitcnt vmcnt(8)
  s_barrier
  s_mov_b32 s22, 131072
  s_mov_b32 s87, 131072
  s_call_b64 s[88:89], F_ldk0
  s_waitcnt vmcnt(32)
  s_barrier
  s_waitcnt vmcnt(24)
  s_barrier
  s_waitcnt vmcnt(8)
  s_barrier
  s_mov_b32 s22, 131072
  s_mov_b32 s87, 0
  s_call_b64 s[88:89], F_ldv0
  s_waitcnt vmcnt(8)
  s_barrier
  s_mov_b32 s22, 131584
  s_mov_b32 s87, 32768
  s_call_b64 s[88:89], F_ldk0
  s_waitcnt vmcnt(8)
  s_barrier
  s_mov_b32 s22, 131584
  s_mov_b32 s87, 65536
  s_call_b64 s[88:89], F_ldv0
  s_waitcnt vmcnt(8)
  s_barrier
  s_mov_b32 s22, 132096
  s_mov_b32 s87, 98304
  s_call_b64 s[88:89], F_ldk0
  s_waitcnt vmcnt(8)
  s_barrier
  s_mov_b32 s22, 132096
  s_mov_b32 s87, 131072
  s_call_b64 s[88:89], F_ldv0
  s_waitcnt vmcnt(8)
  s_barrier
  s_mov_b32 s22, 132608
  s_mov_b32 s87, 0
  s_call_b64 s[88:89], F_ldk0
  s_waitcnt vmcnt(8)
  s_barrier
  s_mov_b32 s22, 132608
  s_mov_b32 s87, 32768
  s_call_b64 s[88:89], F_ldv0
  s_waitcnt vmcnt(8)
  s_barrier
  s_mov_b32 s22, 262144
  s_mov_b32 s87, 65536
  s_call_b64 s[88:89], F_ldk0
  s_waitcnt vmcnt(8)
  s_barrier
  s_mov_b32 s22, 262144
  s_mov_b32 s87, 98304
  s_call_b64 s[88:89], F_ldv0
  s_waitcnt vmcnt(8)
  s_barrier
  s_mov_b32 s22, 262656
  s_mov_b32 s87, 131072
  s_call_b64 s[88:89], F_ldk0
  s_waitcnt vmcnt(8)
  s_barrier
  s_mov_b32 s22, 262656
  s_mov_b32 s87, 0
  s_call_b64 s[88:89], F_ldv0
  s_waitcnt vmcnt(8)
  s_barrier
  s_mov_b32 s22, 263168
  s_mov_b32 s87, 32768
  s_call_b64 s[88:89], F_ldk0
  s_waitcnt vmcnt(8)
  s_barrier
  s_mov_b32 s22, 263168
  s_mov_b32 s87, 65536
  s_call_b64 s[88:89], F_ldv0
  s_waitcnt vmcnt(8)
  s_barrier
  s_mov_b32 s22, 263680
  s_mov_b32 s87, 98304
  s_call_b64 s[88:89], F_ldk0
  s_waitcnt vmcnt(8)
  s_barrier
  s_mov_b32 s22, 263680
  s_mov_b32 s87, 131072
  s_call_b64 s[88:89], F_ldv0
  s_waitcnt vmcnt(8)
  s_barrier
  s_mov_b32 s22, 393216
  s_mov_b32 s87, 0
  s_call_b64 s[88:89], F_ldk0
  s_waitcnt vmcnt(8)
  s_barrier
  s_mov_b32 s22, 393216
  s_mov_b32 s87, 32768
  s_call_b64 s[88:89], F_ldv0
  s_waitcnt vmcnt(8)
  s_barrier
  s_mov_b32 s22, 393728
  s_mov_b32 s87, 65536
  s_call_b64 s[88:89], F_ldk0
  s_waitcnt vmcnt(8)
  s_barrier
  s_mov_b32 s22, 393728
  s_mov_b32 s87, 98304
  s_call_b64 s[88:89], F_ldv0
  s_waitcnt vmcnt(8)
  s_barrier
  s_mov_b32 s22, 394240
  s_mov_b32 s87, 131072
  s_call_b64 s[88:89], F_ldk0
  s_waitcnt vmcnt(8)
  s_barrier
  s_mov_b32 s22, 394240
  s_mov_b32 s87, 0
  s_call_b64 s[88:89], F_ldv0
  s_waitcnt vmcnt(8)
  s_barrier
  s_mov_b32 s22, 394752
  s_mov_b32 s87, 32768
  s_call_b64 s[88:89], F_ldk0
  s_waitcnt vmcnt(8)
  s_barrier
  s_mov_b32 s22, 394752
  s_mov_b32 s87, 65536
  s_call_b64 s[88:89], F_ldv0
  s_waitcnt vmcnt(8)
  s_barrier
  s_mov_b32 s22, 67108864
  s_mov_b32 s87, 98304
  s_call_b64 s[88:89], F_ldk1
  ds_write_b128 v1, v[8:11] offset:4096
  ds_write_b128 v1, v[12:15] offset:5120
  ds_write_b128 v1, v[16:19] offset:6144
  s_waitcnt lgkmcnt(0)
  s_waitcnt vmcnt(8)
  s_barrier
  s_mov_b32 s22, 67108864
  s_mov_b32 s87, 131072
  s_call_b64 s[88:89], F_ldv1
  s_barrier
  s_waitcnt vmcnt(8)
  s_barrier
  s_mov_b32 s22, 67109376
  s_mov_b32 s87, 0
  s_call_b64 s[88:89], F_ldk1
  s_waitcnt vmcnt(8)
  s_barrier
  s_mov_b32 s22, 67109376
  s_mov_b32 s87, 32768
  s_call_b64 s[88:89], F_ldv1
  s_waitcnt vmcnt(8)
  s_barrier
  s_mov_b32 s22, 67109888
  s_mov_b32 s87, 98304
  s_call_b64 s[88:89], F_ldv1
  s_waitcnt vmcnt(63)
  v_add_u32 v5, 65536, v2
  ds_write_b128 v5, v[20:23] offset:0
  ds_write_b128 v5, v[24:27] offset:1024
  ds_write_b128 v5, v[28:31] offset:2048
  ds_write_b128 v5, v[32:35] offset:3072
  ds_write_b128 v5, v[36:39] offset:4096
  ds_write_b128 v5, v[40:43] offset:5120
  ds_write_b128 v5, v[44:47] offset:6144
  ds_write_b128 v5, v[48:51] offset:7168
  s_waitcnt lgkmcnt(0)
  s_waitcnt vmcnt(8)
  s_barrier
  s_mov_b32 s22, 67110400
  s_mov_b32 s87, 131072
  s_call_b64 s[88:89], F_ldk1
  s_barrier
  s_waitcnt vmcnt(8)
  s_barrier
  s_mov_b32 s22, 67110400
  s_mov_b32 s87, 0
  s_call_b64 s[88:89], F_ldv1
  s_waitcnt vmcnt(8)
  s_barrier
  s_mov_b32 s22, 67239936
  s_mov_b32 s87, 65536
  s_call_b64 s[88:89], F_ldv1
  s_waitcnt vmcnt(63)
  v_add_u32 v5, 32768, v2
  ds_write_b128 v5, v[52:55] offset:0
  ds_write_b128 v5, v[56:59] offset:1024
  ds_write_b128 v5, v[60:63] offset:2048
  ds_write_b128 v5, v[64:67] offset:3072
  ds_write_b128 v5, v[68:71] offset:4096
  ds_write_b128 v5, v[72:75] offset:5120
  ds_write_b128 v5, v[76:79] offset:6144
  ds_write_b128 v5, v[80:83] offset:7168
  s_waitcnt lgkmcnt(0)
  s_waitcnt vmcnt(8)
  s_barrier
  s_mov_b32 s22, 67240448
  s_mov_b32 s87, 98304
  s_call_b64 s[88:89], F_ldk1
  s_barrier
  s_waitcnt vmcnt(8)
  s_barrier
  s_mov_b32 s22, 67240448
  s_mov_b32 s87, 131072
  s_call_b64 s[88:89], F_ldv1
  s_waitcnt vmcnt(8)
  s_barrier
  s_mov_b32 s22, 67240960
  s_mov_b32 s87, 32768
  s_call_b64 s[88:89], F_ldv1
  s_waitcnt vmcnt(63)
  v_add_u32 v5, 0, v2
  ds_write_b128 v5, v[84:87] offset:0
  ds_write_b128 v5, v[88:91] offset:1024
  ds_write_b128 v5, v[92:95] offset:2048
  ds_write_b128 v5, v[96:99] offset:3072
  ds_write_b128 v5, v[100:103] offset:4096
  ds_write_b128 v5, v[104:107] offset:5120
  ds_write_b128 v5, v[108:111] offset:6144
  ds_write_b128 v5, v[112:115] offset:7168
  s_waitcnt lgkmcnt(0)
  s_waitcnt vmcnt(8)
  s_barrier
  s_mov_b32 s22, 67241472
  s_mov_b32 s87, 65536
  s_call_b64 s[88:89], F_ldk1
  s_barrier
  s_waitcnt vmcnt(8)
  s_barrier
  s_mov_b32 s22, 67371008
  s_mov_b32 s87, 131072
  s_call_b64 s[88:89], F_ldk1
  s_waitcnt vmcnt(63)
  v_add_u32 v5, 98304, v2
  ds_write_b128 v5, v[116:119] offset:0
  ds_write_b128 v5, v[120:123] offset:1024
  ds_write_b128 v5, v[124:127] offset:2048
  ds_write_b128 v5, v[128:131] offset:3072
  ds_write_b128 v5, v[132:135] offset:4096
  ds_write_b128 v5, v[136:139] offset:5120
  ds_write_b128 v5, v[140:143] offset:6144
  ds_write_b128 v5, v[144:147] offset:7168
  s_waitcnt lgkmcnt(0)
  s_waitcnt vmcnt(8)
  s_barrier
  s_mov_b32 s22, 67371008
  s_mov_b32 s87, 0
  s_call_b64 s[88:89], F_ldv1
  s_barrier
  s_waitcnt vmcnt(8)
  s_barrier
  s_mov_b32 s22, 67371520
  s_mov_b32 s87, 65536
  s_call_b64 s[88:89], F_ldv1
  s_waitcnt vmcnt(63)
  v_add_u32 v5, 32768, v2
  ds_write_b128 v5, v[148:151] offset:0
  ds_write_b128 v5, v[152:155] offset:1024
  ds_write_b128 v5, v[156:159] offset:2048
  ds_write_b128 v5, v[160:163] offset:3072
  ds_write_b128 v5, v[164:167] offset:4096
  ds_write_b128 v5, v[168:171] offset:5120
  ds_write_b128 v5, v[172:175] offset:6144
  ds_write_b128 v5, v[176:179] offset:7168
  s_waitcnt lgkmcnt(0)
  s_waitcnt vmcnt(8)
  s_barrier
  s_mov_b32 s22, 67372032
  s_mov_b32 s87, 98304
  s_call_b64 s[88:89], F_ldk1
  s_barrier
  s_waitcnt vmcnt(8)
  s_barrier
  s_mov_b32 s22, 67372544
  s_mov_b32 s87, 0
  s_call_b64 s[88:89], F_ldk1
  s_waitcnt vmcnt(63)
  v_add_u32 v5, 131072, v2
  ds_write_b128 v5, v[180:183] offset:0
  ds_write_b128 v5, v[184:187] offset:1024
  ds_write_b128 v5, v[188:191] offset:2048
  ds_write_b128 v5, v[192:195] offset:3072
  ds_write_b128 v5, v[196:199] offset:4096
  ds_write_b128 v5, v[200:203] offset:5120
  ds_write_b128 v5, v[204:207] offset:6144
  ds_write_b128 v5, v[208:211] offset:7168
  s_waitcnt lgkmcnt(0)
  s_waitcnt vmcnt(8)
  s_barrier
  s_mov_b32 s22, 67372544
  s_mov_b32 s87, 32768
  s_call_b64 s[88:89], F_ldv1
  s_barrier
  s_waitcnt vmcnt(8)
  s_barrier
  s_mov_b32 s22, 67502080
  s_mov_b32 s87, 98304
  s_call_b64 s[88:89], F_ldv1
  s_waitcnt vmcnt(63)
  v_add_u32 v5, 65536, v2
  ds_write_b128 v5, v[212:215] offset:0
  ds_write_b128 v5, v[216:219] offset:1024
  ds_write_b128 v5, v[220:223] offset:2048
  ds_write_b128 v5, v[224:227] offset:3072
  ds_write_b128 v5, v[228:231] offset:4096
  ds_write_b128 v5, v[232:235] offset:5120
  ds_write_b128 v5, v[236:239] offset:6144
  ds_write_b128 v5, v[240:243] offset:7168
  s_waitcnt lgkmcnt(0)
  s_waitcnt vmcnt(8)
  s_barrier
  s_mov_b32 s22, 67502592
  s_mov_b32 s87, 131072
  s_call_b64 s[88:89], F_ldk1
  s_barrier
  s_waitcnt vmcnt(8)
  s_barrier
  s_mov_b32 s22, 67502592
  s_mov_b32 s87, 0
  s_call_b64 s[88:89], F_ldv1
  s_waitcnt vmcnt(8)
  s_barrier
  s_mov_b32 s22, 67503104
  s_mov_b32 s87, 32768
  s_call_b64 s[88:89], F_ldk1
  s_waitcnt vmcnt(8)
  s_barrier
  s_mov_b32 s22, 67503104
  s_mov_b32 s87, 65536
  s_call_b64 s[88:89], F_ldv1
  s_waitcnt vmcnt(8)
  s_barrier
  s_mov_b32 s22, 67503616
  s_mov_b32 s87, 98304
  s_call_b64 s[88:89], F_ldk1
  s_waitcnt vmcnt(8)
  s_barrier
  s_mov_b32 s22, 67503616
  s_mov_b32 s87, 131072
  s_call_b64 s[88:89], F_ldv1
  s_waitcnt vmcnt(8)
  s_barrier
  s_waitcnt vmcnt(0)
  s_barrier
  s_branch L_fin
F_ldk1:
  s_xor_b32 s20, s23, s22
  s_add_u32 m0, s25, s87
  s_waitcnt vmcnt(15)
  buffer_load_dwordx4 v3, s[72:75], s20 offen nt lds
  s_add_u32 m0, m0, 1024
  s_xor_b32 s20, s20, 4096
  s_waitcnt vmcnt(15)
  buffer_load_dwordx4 v3, s[72:75], s20 offen nt lds
  s_add_u32 m0, m0, 1024
  s_xor_b32 s20, s20, 12288
  s_waitcnt vmcnt(15)
  buffer_load_dwordx4 v4, s[72:75], s20 offen nt lds
  s_add_u32 m0, m0, 1024
  s_xor_b32 s20, s20, 4096
  s_waitcnt vmcnt(15)
  buffer_load_dwordx4 v4, s[72:75], s20 offen nt lds
  s_add_u32 m0, m0, 1024
  s_xor_b32 s20, s20, 28672
  s_waitcnt vmcnt(15)
  buffer_load_dwordx4 v3, s[72:75], s20 offen nt lds
  s_add_u32 m0, m0, 1024
  s_xor_b32 s20, s20, 4096
  s_waitcnt vmcnt(15)
  buffer_load_dwordx4 v3, s[72:75], s20 offen nt lds
  s_add_u32 m0, m0, 1024
  s_xor_b32 s20, s20, 12288
  s_waitcnt vmcnt(15)
  buffer_load_dwordx4 v4, s[72:75], s20 offen nt lds
  s_add_u32 m0, m0, 1024
  s_xor_b32 s20, s20, 4096
  s_waitcnt vmcnt(15)
  buffer_load_dwordx4 v4, s[72:75], s20 offen nt lds
  s_setpc_b64 s[88:89]
F_ldv1:
  s_xor_b32 s20, s23, s22
  s_add_u32 m0, s25, s87
  s_waitcnt vmcnt(15)
  buffer_load_dwordx4 v3, s[76:79], s20 offen nt lds
  s_add_u32 m0, m0, 1024
  s_xor_b32 s20, s20, 4096
  s_waitcnt vmcnt(15)
  buffer_load_dwordx4 v3, s[76:79], s20 offen nt lds
  s_add_u32 m0, m0, 1024
  s_xor_b32 s20, s20, 12288
  s_waitcnt vmcnt(15)
  buffer_load_dwordx4 v4, s[76:79], s20 offen nt lds
  s_add_u32 m0, m0, 1024
  s_xor_b32 s20, s20, 4096
  s_waitcnt vmcnt(15)
  buffer_load_dwordx4 v4, s[76:79], s20 offen nt lds
  s_add_u32 m0, m0, 1024
  s_xor_b32 s20, s20, 28672
  s_waitcnt vmcnt(15)
  buffer_load_dwordx4 v3, s[76:79], s20 offen nt lds
  s_add_u32 m0, m0, 1024
  s_xor_b32 s20, s20, 4096
  s_waitcnt vmcnt(15)
  buffer_load_dwordx4 v3, s[76:79], s20 offen nt lds
  s_add_u32 m0, m0, 1024
  s_xor_b32 s20, s20, 12288
  s_waitcnt vmcnt(15)
  buffer_load_dwordx4 v4, s[76:79], s20 offen nt lds
  s_add_u32 m0, m0, 1024
  s_xor_b32 s20, s20, 4096
  s_waitcnt vmcnt(15)
  buffer_load_dwordx4 v4, s[76:79], s20 offen nt lds
  s_setpc_b64 s[88:89]
L_b_comp:
  s_waitcnt lgkmcnt(0)
  s_mov_b32 s12, s60
  s_mov_b32 s13, s61
  s_mov_b32 s14, 17170432
  s_mov_b32 s15, 0x20000
  s_mov_b32 s16, s58
  s_mov_b32 s17, s59
  s_mov_b32 s18, 256
  s_mov_b32 s19, 0x20000
  s_lshr_b32 s20, s2, 3
  s_xor_b32 s21, s3, 1
  s_or_b32 s20, s20, s21
  s_cbranch_scc1 L_noclr
  v_mov_b32 v8, 0
  v_lshlrev_b32 v5, 7, v0
  s_lshl_b32 s20, s2, 15
  s_add_u32 s20, s20, 12582912
  buffer_store_dword v8, v5, s[12:15], s20 offen sc1
  s_add_u32 s20, s20, 8192
  buffer_store_dword v8, v5, s[12:15], s20 offen sc1
  s_add_u32 s20, s20, 8192
  buffer_store_dword v8, v5, s[12:15], s20 offen sc1
  s_add_u32 s20, s20, 8192
  buffer_store_dword v8, v5, s[12:15], s20 offen sc1
  s_add_u32 s20, s20, 8192
  s_lshl_b32 s20, s2, 2
  v_mov_b32 v6, 1
  s_waitcnt vmcnt(0)
  s_mov_b64 exec, 1
  buffer_store_dword v6, v8, s[16:19], s20 offen sc1
  s_mov_b64 exec, -1
L_noclr:
  s_mov_b32 s68, 0
  s_mov_b32 s67, s3
  s_add_u32 s66, s65, 256
  s_mov_b32 s32, 32768
  s_lshl_b32 s24, s67, 13
  v_lshrrev_b32 v5, 4, v0
  v_and_b32 v6, 15, v0
  v_lshrrev_b32 v7, 2, v6
  v_and_b32 v8, 3, v6
  v_lshl_add_u32 v8, v7, 3, v8
  v_and_b32 v9, 7, v6
  v_lshlrev_b32 v9, 1, v9
  v_xor_b32 v9, v9, v5
  v_lshlrev_b32 v9, 4, v9
  v_lshl_add_u32 v9, v8, 8, v9
  v_add_u32 v1, s24, v9
  v_and_b32 v8, 1, v5
  v_lshl_or_b32 v8, v8, 2, v7
  s_lshl_b32 s20, s67, 1
  v_xor_b32 v8, s20, v8
  v_lshlrev_b32 v8, 5, v8
  v_lshl_add_u32 v7, v5, 3, v7
  v_lshl_add_u32 v8, v7, 8, v8
  v_and_b32 v9, 3, v0
  v_lshl_add_u32 v8, v9, 3, v8
  v_add_u32 v2, s24, v8
  v_mov_b64 v[20:21], 0
  v_mov_b64 v[22:23], 0
  v_mov_b64 v[24:25], 0
  v_mov_b64 v[26:27], 0
  v_mov_b64 v[28:29], 0
  v_mov_b64 v[30:31], 0
  s_mov_b32 s69, 0xff800000
  s_mov_b32 s70, 0xff800000
  s_mov_b32 s87, 0
  v_mov_b32 v16, 0x3f803f80
  v_mov_b32 v17, 0x3f803f80
  v_mov_b32 v18, 0x3f803f80
  v_mov_b32 v19, 0x3f803f80
  v_mov_b64 v[32:33], 0
  v_mov_b64 v[34:35], 0
  v_mov_b64 v[36:37], 0
  v_mov_b64 v[38:39], 0
  v_mov_b64 v[40:41], 0
  v_mov_b64 v[42:43], 0
  v_mov_b64 v[152:153], 0
  v_mov_b64 v[154:155], 0
  v_mov_b64 v[156:157], 0
  v_mov_b64 v[158:159], 0
  v_mov_b64 v[160:161], 0
  v_mov_b64 v[162:163], 0
  v_mov_b64 v[164:165], 0
  v_mov_b64 v[166:167], 0
  v_mov_b64 v[168:169], 0
  v_mov_b64 v[170:171], 0
  v_mov_b64 v[172:173], 0
  v_mov_b64 v[174:175], 0
  v_mov_b64 v[176:177], 0
  v_mov_b64 v[178:179], 0
  v_mov_b64 v[180:181], 0
  v_mov_b64 v[182:183], 0
  v_mov_b64 v[184:185], 0
  v_mov_b64 v[186:187], 0
  v_mov_b64 v[188:189], 0
  v_mov_b64 v[190:191], 0
  v_mov_b64 v[192:193], 0
  v_mov_b64 v[194:195], 0
  v_mov_b64 v[196:197], 0
  v_mov_b64 v[198:199], 0
  v_mov_b64 v[200:201], 0
  v_mov_b64 v[202:203], 0
  v_mov_b64 v[204:205], 0
  v_mov_b64 v[206:207], 0
  v_mov_b64 v[208:209], 0
  v_mov_b64 v[210:211], 0
  v_mov_b64 v[212:213], 0
  v_mov_b64 v[214:215], 0
  v_mov_b64 v[216:217], 0
  v_mov_b64 v[218:219], 0
  v_mov_b64 v[220:221], 0
  v_mov_b64 v[222:223], 0
  v_mov_b64 v[224:225], 0
  v_mov_b64 v[226:227], 0
  v_mov_b64 v[228:229], 0
  v_mov_b64 v[230:231], 0
  v_mov_b64 v[232:233], 0
  v_mov_b64 v[234:235], 0
  v_mov_b64 v[236:237], 0
  v_mov_b64 v[238:239], 0
  v_mov_b64 v[240:241], 0
  v_mov_b64 v[242:243], 0
  v_mov_b64 v[244:245], 0
  v_mov_b64 v[246:247], 0
  v_add_u32 v248, s32, v1
  v_xor_b32 v249, 64, v248
  v_xor_b32 v250, 128, v248
  v_xor_b32 v251, 192, v248
  s_mov_b32 s28, 0
  s_add_u32 s33, s32, 32768
  s_cmp_eq_u32 s33, 163840
  s_cselect_b32 s33, 0, s33
  v_add_u32 v8, s33, v2
  v_xor_b32 v9, 32, v8
  v_xor_b32 v10, 64, v8
  v_xor_b32 v11, 96, v8
  v_xor_b32 v12, 128, v8
  v_xor_b32 v13, 160, v8
  v_xor_b32 v14, 192, v8
  v_xor_b32 v15, 224, v8
  s_barrier
  ds_read_b128 v[100:103], v251 offset:1024
  ds_read_b128 v[72:75], v248 offset:0
  ds_read_b128 v[76:79], v248 offset:1024
  ds_read_b128 v[80:83], v249 offset:0
  ds_read_b128 v[84:87], v249 offset:1024
  ds_read_b128 v[88:91], v250 offset:0
  ds_read_b128 v[92:95], v250 offset:1024
  ds_read_b128 v[96:99], v251 offset:0
  ds_read_b64_tr_b16 v[216:217], v8
  ds_read_b64_tr_b16 v[218:219], v8 offset:1024
  ds_read_b64_tr_b16 v[220:221], v9
  ds_read_b64_tr_b16 v[222:223], v9 offset:1024
  ds_read_b64_tr_b16 v[224:225], v10
  ds_read_b64_tr_b16 v[226:227], v10 offset:1024
  ds_read_b64_tr_b16 v[228:229], v11
  ds_read_b64_tr_b16 v[230:231], v11 offset:1024
  ds_read_b64_tr_b16 v[232:233], v12
  ds_read_b64_tr_b16 v[234:235], v12 offset:1024
  ds_read_b64_tr_b16 v[236:237], v13
  ds_read_b64_tr_b16 v[238:239], v13 offset:1024
  ds_read_b64_tr_b16 v[240:241], v14
  ds_read_b64_tr_b16 v[242:243], v14 offset:1024
  ds_read_b64_tr_b16 v[244:245], v15
  ds_read_b64_tr_b16 v[246:247], v15 offset:1024
  s_waitcnt lgkmcnt(0)
  s_barrier
  v_and_b32 v5, 7, v0
  v_lshlrev_b32 v5, 2, v5
  s_mov_b32 s71, 0
L_poll1:
  buffer_load_dword v6, v5, s[16:19], 0 offen sc1
  s_waitcnt vmcnt(0)
  v_cmp_ne_u32 vcc, 1, v6
  s_cbranch_vccz L_polld2
  s_sleep 32
  s_add_u32 s71, s71, 1
  s_cmp_lt_u32 s71, 0x20000
  s_cbranch_scc1 L_poll1
L_polld2:
  v_mov_b32 v5, 0
  s_lshl_b32 s20, s65, 2
  s_add_u32 s20, s20, s3
  s_lshl_b32 s20, s20, 7
  s_add_u32 s20, s20, 12779520
  s_mov_b32 s71, 0
L_b_sp:
  s_load_dword s21, s[60:61], s20 glc
  s_add_u32 s71, s71, 1
  s_waitcnt lgkmcnt(0)
  s_cmp_eq_u32 s21, 1
  s_cbranch_scc1 L_b_spd
  s_sleep 8
  s_cmp_lt_u32 s71, 24
  s_cbranch_scc1 L_b_sp
  s_mov_b32 s71, 0
L_poll3:
  buffer_load_dword v6, v5, s[12:15], s20 offen sc1
  s_waitcnt vmcnt(0)
  v_cmp_ne_u32 vcc, 1, v6
  s_cbranch_vccz L_polld4
  s_sleep 32
  s_add_u32 s71, s71, 1
  s_cmp_lt_u32 s71, 0x20000
  s_cbranch_scc1 L_poll3
L_polld4:
L_b_spd:
  s_mul_i32 s20, s65, 24576
  s_mul_i32 s21, s3, 6144
  s_add_u32 m0, s21, 4096
  s_add_u32 s20, s20, s21
  s_add_u32 s20, s20, 9437184
  v_lshlrev_b32 v5, 4, v0
  buffer_load_dwordx4 v5, s[12:15], s20 offen sc1 lds
  buffer_load_dwordx4 v5, s[12:15], s20 offen offset:1024 sc1 lds
  buffer_load_dwordx4 v5, s[12:15], s20 offen offset:2048 sc1 lds
  s_add_u32 m0, m0, 3072
  s_add_u32 s20, s20, 3072
  buffer_load_dwordx4 v5, s[12:15], s20 offen sc1 lds
  buffer_load_dwordx4 v5, s[12:15], s20 offen offset:1024 sc1 lds
  buffer_load_dwordx4 v5, s[12:15], s20 offen offset:2048 sc1 lds
  s_waitcnt vmcnt(0)
  s_barrier
L_b_item:
  v_lshlrev_b32 v7, 4, v0
  v_add_u32 v7, 4096, v7
  ds_read_b128 v[104:107], v7 offset:0
  ds_read_b128 v[108:111], v7 offset:1024
  ds_read_b128 v[112:115], v7 offset:2048
  ds_read_b128 v[116:119], v7 offset:3072
  ds_read_b128 v[120:123], v7 offset:4096
  ds_read_b128 v[124:127], v7 offset:5120
  ds_read_b128 v[128:131], v7 offset:6144
  ds_read_b128 v[132:135], v7 offset:7168
  ds_read_b128 v[136:139], v7 offset:8192
  ds_read_b128 v[140:143], v7 offset:9216
  ds_read_b128 v[144:147], v7 offset:10240
  ds_read_b128 v[148:151], v7 offset:11264
  s_waitcnt lgkmcnt(0)
  s_barrier
  s_cmp_lt_u32 s66, 384
  s_cbranch_scc1 L_b_in2
  v_mov_b64 v[20:21], 0
  v_mov_b64 v[22:23], 0
  v_mov_b64 v[24:25], 0
  v_mov_b64 v[26:27], 0
  v_mov_b64 v[28:29], 0
  v_mov_b64 v[30:31], 0
  s_mov_b32 s69, 0xff800000
  s_mov_b32 s70, 0xff800000
  s_mov_b32 s87, 0
  v_mov_b32 v16, 0x3f803f80
  v_mov_b32 v17, 0x3f803f80
  v_mov_b32 v18, 0x3f803f80
  v_mov_b32 v19, 0x3f803f80
  v_mov_b64 v[32:33], 0
  v_mov_b64 v[34:35], 0
  v_mov_b64 v[36:37], 0
  v_mov_b64 v[38:39], 0
  v_mov_b64 v[40:41], 0
  v_mov_b64 v[42:43], 0
  v_mov_b64 v[152:153], 0
  v_mov_b64 v[154:155], 0
  v_mov_b64 v[156:157], 0
  v_mov_b64 v[158:159], 0
  v_mov_b64 v[160:161], 0
  v_mov_b64 v[162:163], 0
  v_mov_b64 v[164:165], 0
  v_mov_b64 v[166:167], 0
  v_mov_b64 v[168:169], 0
  v_mov_b64 v[170:171], 0
  v_mov_b64 v[172:173], 0
  v_mov_b64 v[174:175], 0
  v_mov_b64 v[176:177], 0
  v_mov_b64 v[178:179], 0
  v_mov_b64 v[180:181], 0
  v_mov_b64 v[182:183], 0
  v_mov_b64 v[184:185], 0
  v_mov_b64 v[186:187], 0
  v_mov_b64 v[188:189], 0
  v_mov_b64 v[190:191], 0
  v_mov_b64 v[192:193], 0
  v_mov_b64 v[194:195], 0
  v_mov_b64 v[196:197], 0
  v_mov_b64 v[198:199], 0
  v_mov_b64 v[200:201], 0
  v_mov_b64 v[202:203], 0
  v_mov_b64 v[204:205], 0
  v_mov_b64 v[206:207], 0
  v_mov_b64 v[208:209], 0
  v_mov_b64 v[210:211], 0
  v_mov_b64 v[212:213], 0
  v_mov_b64 v[214:215], 0
  v_mov_b64 v[216:217], 0
  v_mov_b64 v[218:219], 0
  v_mov_b64 v[220:221], 0
  v_mov_b64 v[222:223], 0
  v_mov_b64 v[224:225], 0
  v_mov_b64 v[226:227], 0
  v_mov_b64 v[228:229], 0
  v_mov_b64 v[230:231], 0
  v_mov_b64 v[232:233], 0
  v_mov_b64 v[234:235], 0
  v_mov_b64 v[236:237], 0
  v_mov_b64 v[238:239], 0
  v_mov_b64 v[240:241], 0
  v_mov_b64 v[242:243], 0
  v_mov_b64 v[244:245], 0
  v_mov_b64 v[246:247], 0
  v_add_u32 v248, s32, v1
  v_xor_b32 v249, 64, v248
  v_xor_b32 v250, 128, v248
  v_xor_b32 v251, 192, v248
  s_mov_b32 s28, 0
  s_branch L_b_in
L_b_loop:
  v_add_u32 v248, s32, v1
  v_xor_b32 v249, 64, v248
  v_xor_b32 v250, 128, v248
  v_xor_b32 v251, 192, v248
  s_barrier
L_b_in:
  ds_read_b128 v[100:103], v251 offset:1024
  ds_read_b128 v[72:75], v248 offset:0
  ds_read_b128 v[76:79], v248 offset:1024
  ds_read_b128 v[80:83], v249 offset:0
  ds_read_b128 v[84:87], v249 offset:1024
  ds_read_b128 v[88:91], v250 offset:0
  ds_read_b128 v[92:95], v250 offset:1024
  ds_read_b128 v[96:99], v251 offset:0
  s_add_u32 s33, s32, 32768
  s_cmp_eq_u32 s33, 163840
  s_cselect_b32 s33, 0, s33
  v_add_u32 v8, s33, v2
  v_xor_b32 v9, 32, v8
  v_xor_b32 v10, 64, v8
  v_xor_b32 v11, 96, v8
  v_xor_b32 v12, 128, v8
  v_xor_b32 v13, 160, v8
  v_xor_b32 v14, 192, v8
  v_xor_b32 v15, 224, v8
L_b_in2:
  s_waitcnt lgkmcnt(6)
  v_mfma_f32_16x16x32_bf16 v[44:47], v[72:75], v[104:107], v[20:23]
  v_mfma_f32_16x16x32_bf16 v[52:55], v[72:75], v[108:111], v[24:27]
  v_mfma_f32_16x16x32_bf16 v[60:63], v[72:75], v[112:115], v[28:31]
  s_waitcnt lgkmcnt(5)
  v_mfma_f32_16x16x32_bf16 v[48:51], v[76:79], v[104:107], v[20:23]
  v_mfma_f32_16x16x32_bf16 v[56:59], v[76:79], v[108:111], v[24:27]
  v_mfma_f32_16x16x32_bf16 v[64:67], v[76:79], v[112:115], v[28:31]
  s_waitcnt lgkmcnt(4)
  v_mfma_f32_16x16x32_bf16 v[44:47], v[80:83], v[116:119], v[44:47]
  v_mfma_f32_16x16x32_bf16 v[52:55], v[80:83], v[120:123], v[52:55]
  v_mfma_f32_16x16x32_bf16 v[60:63], v[80:83], v[124:127], v[60:63]
  s_waitcnt lgkmcnt(3)
  v_mfma_f32_16x16x32_bf16 v[48:51], v[84:87], v[116:119], v[48:51]
  v_mfma_f32_16x16x32_bf16 v[56:59], v[84:87], v[120:123], v[56:59]
  v_mfma_f32_16x16x32_bf16 v[64:67], v[84:87], v[124:127], v[64:67]
  s_waitcnt lgkmcnt(2)
  v_mfma_f32_16x16x32_bf16 v[44:47], v[88:91], v[128:131], v[44:47]
  v_mfma_f32_16x16x32_bf16 v[52:55], v[88:91], v[132:135], v[52:55]
  v_mfma_f32_16x16x32_bf16 v[60:63], v[88:91], v[136:139], v[60:63]
  s_waitcnt lgkmcnt(1)
  v_mfma_f32_16x16x32_bf16 v[48:51], v[92:95], v[128:131], v[48:51]
  v_mfma_f32_16x16x32_bf16 v[56:59], v[92:95], v[132:135], v[56:59]
  v_mfma_f32_16x16x32_bf16 v[64:67], v[92:95], v[136:139], v[64:67]
  s_waitcnt lgkmcnt(0)
  v_mfma_f32_16x16x32_bf16 v[44:47], v[96:99], v[140:143], v[44:47]
  v_mfma_f32_16x16x32_bf16 v[52:55], v[96:99], v[144:147], v[52:55]
  v_mfma_f32_16x16x32_bf16 v[60:63], v[96:99], v[148:151], v[60:63]
  v_mfma_f32_16x16x32_bf16 v[48:51], v[100:103], v[140:143], v[48:51]
  v_mfma_f32_16x16x32_bf16 v[56:59], v[100:103], v[144:147], v[56:59]
  v_mfma_f32_16x16x32_bf16 v[64:67], v[100:103], v[148:151], v[64:67]
  s_nop 2
  v_max3_f32 v5, v44, v45, v46
  v_max3_f32 v6, v47, v52, v53
  v_max3_f32 v5, v54, v55, v5
  v_max3_f32 v6, v60, v61, v6
  v_max3_f32 v5, v62, v63, v5
  v_max3_f32 v6, v48, v49, v6
  v_max3_f32 v5, v50, v51, v5
  v_max3_f32 v6, v56, v57, v6
  v_max3_f32 v5, v58, v59, v5
  v_max3_f32 v6, v64, v65, v6
  v_max3_f32 v5, v66, v67, v5
  v_max_f32 v5, v5, v6
  v_cmp_nge_f32 vcc, s69, v5
  s_cbranch_vccz L_sm5
  s_call_b64 s[88:89], F_rare
L_sm5:
  v_exp_f32 v44, v44
  v_exp_f32 v45, v45
  v_exp_f32 v46, v46
  v_exp_f32 v47, v47
  v_exp_f32 v48, v48
  v_exp_f32 v49, v49
  v_exp_f32 v50, v50
  v_exp_f32 v51, v51
  v_cvt_pk_bf16_f32 v44, v44, v45
  v_cvt_pk_bf16_f32 v45, v46, v47
  v_cvt_pk_bf16_f32 v46, v48, v49
  v_cvt_pk_bf16_f32 v47, v50, v51
  v_exp_f32 v52, v52
  v_exp_f32 v53, v53
  v_exp_f32 v54, v54
  v_exp_f32 v55, v55
  v_exp_f32 v56, v56
  v_exp_f32 v57, v57
  v_exp_f32 v58, v58
  v_exp_f32 v59, v59
  v_cvt_pk_bf16_f32 v52, v52, v53
  v_cvt_pk_bf16_f32 v53, v54, v55
  v_cvt_pk_bf16_f32 v54, v56, v57
  v_cvt_pk_bf16_f32 v55, v58, v59
  v_exp_f32 v60, v60
  v_exp_f32 v61, v61
  v_exp_f32 v62, v62
  v_exp_f32 v63, v63
  v_exp_f32 v64, v64
  v_exp_f32 v65, v65
  v_exp_f32 v66, v66
  v_exp_f32 v67, v67
  v_cvt_pk_bf16_f32 v60, v60, v61
  v_cvt_pk_bf16_f32 v61, v62, v63
  v_cvt_pk_bf16_f32 v62, v64, v65
  v_cvt_pk_bf16_f32 v63, v66, v67
  v_mfma_f32_16x16x32_bf16 v[32:35], v[16:19], v[44:47], v[32:35]
  v_mfma_f32_16x16x32_bf16 v[36:39], v[16:19], v[52:55], v[36:39]
  v_mfma_f32_16x16x32_bf16 v[40:43], v[16:19], v[60:63], v[40:43]
  s_add_u32 s32, s33, 32768
  s_cmp_eq_u32 s32, 163840
  s_cselect_b32 s32, 0, s32
  s_cmp_le_u32 s28, 1
  s_cbranch_scc1 L_b_early
  s_cmp_eq_u32 s28, 15
  s_cbranch_scc1 L_b_last
L_b_now:
  s_barrier
  ds_read_b64_tr_b16 v[76:77], v10 offset:0
  ds_read_b64_tr_b16 v[78:79], v10 offset:1024
  ds_read_b64_tr_b16 v[80:81], v11 offset:0
  ds_read_b64_tr_b16 v[82:83], v11 offset:1024
  ds_read_b64_tr_b16 v[84:85], v12 offset:0
  ds_read_b64_tr_b16 v[86:87], v12 offset:1024
  ds_read_b64_tr_b16 v[88:89], v13 offset:0
  ds_read_b64_tr_b16 v[90:91], v13 offset:1024
  ds_read_b64_tr_b16 v[92:93], v14 offset:0
  ds_read_b64_tr_b16 v[94:95], v14 offset:1024
  ds_read_b64_tr_b16 v[96:97], v15 offset:0
  ds_read_b64_tr_b16 v[98:99], v15 offset:1024
  ds_read_b64_tr_b16 v[68:69], v8 offset:0
  ds_read_b64_tr_b16 v[70:71], v8 offset:1024
  ds_read_b64_tr_b16 v[72:73], v9 offset:0
  ds_read_b64_tr_b16 v[74:75], v9 offset:1024
L_b_pv:
  s_waitcnt lgkmcnt(14)
  v_mfma_f32_16x16x32_bf16 v[176:179], v[76:79], v[44:47], v[176:179]
  v_mfma_f32_16x16x32_bf16 v[180:183], v[76:79], v[52:55], v[180:183]
  v_mfma_f32_16x16x32_bf16 v[184:187], v[76:79], v[60:63], v[184:187]
  s_waitcnt lgkmcnt(12)
  v_mfma_f32_16x16x32_bf16 v[188:191], v[80:83], v[44:47], v[188:191]
  v_mfma_f32_16x16x32_bf16 v[192:195], v[80:83], v[52:55], v[192:195]
  v_mfma_f32_16x16x32_bf16 v[196:199], v[80:83], v[60:63], v[196:199]
  s_waitcnt lgkmcnt(10)
  v_mfma_f32_16x16x32_bf16 v[200:203], v[84:87], v[44:47], v[200:203]
  v_mfma_f32_16x16x32_bf16 v[204:207], v[84:87], v[52:55], v[204:207]
  v_mfma_f32_16x16x32_bf16 v[208:211], v[84:87], v[60:63], v[208:211]
  s_waitcnt lgkmcnt(8)
  v_mfma_f32_16x16x32_bf16 v[212:215], v[88:91], v[44:47], v[212:215]
  v_mfma_f32_16x16x32_bf16 v[216:219], v[88:91], v[52:55], v[216:219]
  v_mfma_f32_16x16x32_bf16 v[220:223], v[88:91], v[60:63], v[220:223]
  s_waitcnt lgkmcnt(6)
  v_mfma_f32_16x16x32_bf16 v[224:227], v[92:95], v[44:47], v[224:227]
  v_mfma_f32_16x16x32_bf16 v[228:231], v[92:95], v[52:55], v[228:231]
  v_mfma_f32_16x16x32_bf16 v[232:235], v[92:95], v[60:63], v[232:235]
  s_waitcnt lgkmcnt(4)
  v_mfma_f32_16x16x32_bf16 v[236:239], v[96:99], v[44:47], v[236:239]
  v_mfma_f32_16x16x32_bf16 v[240:243], v[96:99], v[52:55], v[240:243]
  v_mfma_f32_16x16x32_bf16 v[244:247], v[96:99], v[60:63], v[244:247]
  s_waitcnt lgkmcnt(2)
  v_mfma_f32_16x16x32_bf16 v[152:155], v[68:71], v[44:47], v[152:155]
  v_mfma_f32_16x16x32_bf16 v[156:159], v[68:71], v[52:55], v[156:159]
  v_mfma_f32_16x16x32_bf16 v[160:163], v[68:71], v[60:63], v[160:163]
  s_waitcnt lgkmcnt(0)
  v_mfma_f32_16x16x32_bf16 v[164:167], v[72:75], v[44:47], v[164:167]
  v_mfma_f32_16x16x32_bf16 v[168:171], v[72:75], v[52:55], v[168:171]
  v_mfma_f32_16x16x32_bf16 v[172:175], v[72:75], v[60:63], v[172:175]
  s_add_u32 s28, s28, 1
  s_branch L_b_loop
L_b_last:
  s_lshl_b32 s30, s66, 7
  s_add_u32 s30, s30, 12582912
  s_mul_i32 s20, s68, 36864
  s_xor_b32 s21, s67, 1
  s_mul_i32 s21, s21, 9216
  s_add_u32 s21, s21, 16384
  s_add_u32 s4, s21, s20
  s_xor_b32 s21, s67, 2
  s_mul_i32 s21, s21, 9216
  s_add_u32 s21, s21, 19456
  s_add_u32 s5, s21, s20
  s_xor_b32 s21, s67, 3
  s_mul_i32 s21, s21, 9216
  s_add_u32 s21, s21, 22528
  s_add_u32 s6, s21, s20
  s_mul_i32 s21, s67, 9216
  s_add_u32 s21, s21, 16384
  s_add_u32 s7, s21, s20
  s_add_u32 s27, s66, s68
  s_lshl_b32 s27, s27, 2
  s_add_u32 s27, s27, s67
  s_mul_i32 s27, s27, 3072
  s_mul_i32 s20, s68, 192
  s_add_u32 s20, s20, s67
  s_lshl_b32 s20, s20, 3
  s_add_u32 s20, s20, 0
  s_lshl_b32 s21, s68, 4
  s_add_u32 s21, s21, 0
  s_lshl_b32 s26, s67, 2
  s_add_u32 s26, s26, s21
  s_barrier
  ds_read_b64_tr_b16 v[76:77], v10 offset:0
  ds_read_b64_tr_b16 v[78:79], v10 offset:1024
  ds_read_b64_tr_b16 v[80:81], v11 offset:0
  ds_read_b64_tr_b16 v[82:83], v11 offset:1024
  ds_read_b64_tr_b16 v[84:85], v12 offset:0
  ds_read_b64_tr_b16 v[86:87], v12 offset:1024
  ds_read_b64_tr_b16 v[88:89], v13 offset:0
  ds_read_b64_tr_b16 v[90:91], v13 offset:1024
  ds_read_b64_tr_b16 v[92:93], v14 offset:0
  ds_read_b64_tr_b16 v[94:95], v14 offset:1024
  ds_read_b64_tr_b16 v[96:97], v15 offset:0
  ds_read_b64_tr_b16 v[98:99], v15 offset:1024
  ds_read_b64_tr_b16 v[68:69], v8 offset:0
  ds_read_b64_tr_b16 v[70:71], v8 offset:1024
  ds_read_b64_tr_b16 v[72:73], v9 offset:0
  ds_read_b64_tr_b16 v[74:75], v9 offset:1024
  s_call_b64 s[88:89], F_last
  s_add_u32 s66, s66, 128
  s_cmp_lt_u32 s66, 512
  s_cbranch_scc1 L_b_item
  v_mov_b32 v5, 0
  s_waitcnt vmcnt(0)
  s_barrier
  s_cmp_eq_u32 s3, 0
  s_cbranch_scc0 L_fin
  v_mov_b32 v6, 1
  s_mov_b64 exec, 1
  buffer_store_dword v6, v5, s[12:15], s30 offen sc1
  s_mov_b64 exec, -1
  s_branch L_fin
L_b_early:
  s_cmp_ge_u32 s66, 384
  s_cbranch_scc1 L_b_e1
  s_cmp_eq_u32 s28, 0
  s_cbranch_scc0 L_b_now
  s_barrier
  v_mov_b64 v[68:69], v[216:217]
  v_mov_b64 v[70:71], v[218:219]
  v_mov_b64 v[72:73], v[220:221]
  v_mov_b64 v[74:75], v[222:223]
  v_mov_b64 v[76:77], v[224:225]
  v_mov_b64 v[78:79], v[226:227]
  v_mov_b64 v[80:81], v[228:229]
  v_mov_b64 v[82:83], v[230:231]
  v_mov_b64 v[84:85], v[232:233]
  v_mov_b64 v[86:87], v[234:235]
  v_mov_b64 v[88:89], v[236:237]
  v_mov_b64 v[90:91], v[238:239]
  v_mov_b64 v[92:93], v[240:241]
  v_mov_b64 v[94:95], v[242:243]
  v_mov_b64 v[96:97], v[244:245]
  v_mov_b64 v[98:99], v[246:247]
  v_mov_b64 v[216:217], 0
  v_mov_b64 v[218:219], 0
  v_mov_b64 v[220:221], 0
  v_mov_b64 v[222:223], 0
  v_mov_b64 v[224:225], 0
  v_mov_b64 v[226:227], 0
  v_mov_b64 v[228:229], 0
  v_mov_b64 v[230:231], 0
  v_mov_b64 v[232:233], 0
  v_mov_b64 v[234:235], 0
  v_mov_b64 v[236:237], 0
  v_mov_b64 v[238:239], 0
  v_mov_b64 v[240:241], 0
  v_mov_b64 v[242:243], 0
  v_mov_b64 v[244:245], 0
  v_mov_b64 v[246:247], 0
  s_branch L_b_pv
L_b_e1:
  s_waitcnt vmcnt(0)
  s_xor_b32 s20, s28, 1
  s_or_b32 s20, s20, s3
  s_cbranch_scc1 L_b_now
  v_mov_b32 v5, 0
  v_mov_b32 v6, 1
  s_mov_b64 exec, 1
  buffer_store_dword v6, v5, s[12:15], s30 offen sc1
  s_mov_b64 exec, -1
  s_branch L_b_now
L_ypart:
  s_add_u32 s27, s22, s23
  s_and_b32 s27, s27, 3
  s_and_b32 s20, s62, 3
  s_lshl_b32 s20, s20, 2
  s_or_b32 s27, s27, s20
  s_and_b32 s83, s62, 1
  s_lshr_b32 s82, s62, 1
  s_lshl_b32 s82, s82, 2
  s_add_u32 s82, s82, s23
  s_lshl_b32 s20, s83, 2
  s_add_u32 s81, s20, s22
  s_lshl_b32 s66, s81, 4
  s_add_u32 s66, s66, s82
  s_lshl_b32 s66, s66, 1
  v_lshrrev_b32 v5, 4, v0
  v_and_b32 v6, 15, v0
  s_cmp_eq_u32 s35, 0
  s_cbranch_scc1 L_q_comp
  s_and_b32 s24, s3, 3
  v_lshlrev_b32 v7, 1, v5
  v_xor_b32 v7, v7, v6
  v_lshlrev_b32 v7, 4, v7
  v_lshl_add_u32 v7, v5, 13, v7
  s_lshl_b32 s20, s24, 17
  v_add_u32 v8, s20, v7
  v_add_u32 v9, 31744, v8
  v_xor_b32 v10, 128, v8
  v_add_u32 v10, 63488, v10
  v_add_u32 v11, 31744, v10
  v_lshrrev_b32 v7, 3, v0
  v_and_b32 v16, 7, v0
  s_and_b32 s20, s24, 1
  s_mul_i32 s20, s20, 24
  s_mul_i32 s26, s24, 3072
  s_add_u32 s26, s26, 16384
  s_lshr_b32 s22, s24, 1
  s_mul_i32 s22, s22, 393216
  v_add_u32 v7, s20, v7
  v_and_b32 v17, 6, v7
  v_xor_b32 v17, v17, v16
  v_lshlrev_b32 v17, 4, v17
  v_lshl_add_u32 v17, v7, 11, v17
  v_add_u32 v12, s22, v17
  v_add_u32 v13, 15360, v12
  v_add_u32 v14, 15360, v13
  s_lshl_b32 s25, s24, 12
  s_mov_b32 s87, 0
  s_mov_b32 s33, 0
  s_lshr_b32 s22, s63, 2
  s_mul_i32 s22, s22, 98304
  s_and_b32 s20, s65, 31
  s_lshl_b32 s20, s20, 8
  s_sub_u32 s21, 8388608, s20
  s_waitcnt lgkmcnt(0)
  s_add_u32 s8, s52, s20
  s_addc_u32 s9, s53, 0
  s_mov_b32 s10, s21
  s_mov_b32 s11, 0x20000
  s_add_u32 s4, s46, s22
  s_addc_u32 s5, s47, 0
  s_mov_b32 s6, 491520
  s_mov_b32 s7, 0x20000
L_qb_ll:
  s_cmp_lt_u32 s33, 3
  s_cbranch_scc1 L_qb_li
  s_waitcnt vmcnt(14)
  s_barrier
L_qb_li:
  s_xor_b32 s20, s27, s33
  s_lshl_b32 s21, s20, 19
  s_add_u32 m0, s25, s87
  s_lshl_b32 s20, s20, 7
  buffer_load_dwordx4 v8, s[8:11], s21 offen lds
  buffer_load_dwordx4 v9, s[8:11], s21 offen offset:1024 lds
  buffer_load_dwordx4 v10, s[8:11], s21 offen offset:2048 lds
  buffer_load_dwordx4 v11, s[8:11], s21 offen offset:3072 lds
  s_add_u32 m0, s26, s87
  s_add_u32 s33, s33, 1
  buffer_load_dwordx4 v12, s[4:7], s20 offen lds
  buffer_load_dwordx4 v13, s[4:7], s20 offen offset:1024 lds
  buffer_load_dwordx4 v14, s[4:7], s20 offen offset:2048 lds
  s_add_u32 s87, s87, 40960
  s_cmp_eq_u32 s87, 163840
  s_cselect_b32 s87, 0, s87
  s_cmp_lt_u32 s33, 16
  s_cbranch_scc1 L_qb_ll
  v_lshrrev_b32 v7, 3, v0
  v_and_b32 v16, 7, v0
  s_mul_i32 s20, s24, 12
  s_mul_i32 s30, s24, 1536
  s_add_u32 s30, s30, 32768
  s_mov_b32 s22, 0
  v_add_u32 v7, s20, v7
  v_and_b32 v17, 6, v7
  v_xor_b32 v17, v17, v16
  v_lshlrev_b32 v17, 4, v17
  v_lshl_add_u32 v17, v7, 11, v17
  v_add_u32 v18, s22, v17
  v_add_u32 v19, 15360, v18
  s_mul_i32 s20, s81, 98304
  s_add_u32 s72, s36, s20
  s_addc_u32 s73, s37, 0
  s_mov_b32 s74, 98304
  s_mov_b32 s75, 0x20000
  s_lshl_b32 s20, s82, 9
  s_sub_u32 s21, 8388608, s20
  s_add_u32 s76, s42, s20
  s_addc_u32 s77, s43, 0
  s_mov_b32 s78, s21
  s_mov_b32 s79, 0x20000
  s_mov_b32 s12, s60
  s_mov_b32 s13, s61
  s_mov_b32 s14, 17170432
  s_mov_b32 s15, 0x20000
  s_mov_b32 s33, 0
L_qa_ll:
  s_cmp_lt_u32 s33, 3
  s_cbranch_scc1 L_qa_w
  s_waitcnt vmcnt(20)
L_qa_wj:
  s_barrier
L_qa_wk:
  s_xor_b32 s20, s27, s33
  s_lshl_b32 s21, s20, 19
  s_add_u32 m0, s25, s87
  s_lshl_b32 s20, s20, 7
  buffer_load_dwordx4 v8, s[76:79], s21 offen lds
  buffer_load_dwordx4 v9, s[76:79], s21 offen offset:1024 lds
  buffer_load_dwordx4 v10, s[76:79], s21 offen offset:2048 lds
  buffer_load_dwordx4 v11, s[76:79], s21 offen offset:3072 lds
  s_add_u32 m0, m0, 16384
  s_add_u32 s21, s21, 256
  buffer_load_dwordx4 v8, s[76:79], s21 offen lds
  buffer_load_dwordx4 v9, s[76:79], s21 offen offset:1024 lds
  buffer_load_dwordx4 v10, s[76:79], s21 offen offset:2048 lds
  buffer_load_dwordx4 v11, s[76:79], s21 offen offset:3072 lds
  s_add_u32 m0, s30, s87
  s_add_u32 s33, s33, 1
  buffer_load_dwordx4 v18, s[72:75], s20 offen lds
  s_mov_b32 exec_hi, 0
  buffer_load_dwordx4 v19, s[72:75], s20 offen offset:1024 lds
  s_mov_b32 exec_hi, -1
  s_add_u32 s87, s87, 40960
  s_cmp_eq_u32 s87, 163840
  s_cselect_b32 s87, 0, s87
  s_cmp_lt_u32 s33, 16
  s_cbranch_scc1 L_qa_ll
  v_lshrrev_b32 v5, 4, v0
  v_and_b32 v6, 15, v0
  v_lshlrev_b32 v7, 1, v5
  v_xor_b32 v7, v7, v6
  v_lshlrev_b32 v7, 4, v7
  v_lshl_add_u32 v3, v5, 8, v7
  v_xor_b32 v4, 128, v3
  s_and_b32 s29, s63, 3
  s_lshl_b32 s20, s81, 2
  s_or_b32 s29, s29, s20
  s_lshr_b32 s21, s62, 1
  s_add_u32 s20, s20, s21
  s_lshl_b32 s20, s20, 19
  s_add_u32 s4, s38, s20
  s_addc_u32 s5, s39, 0
  s_mov_b32 s6, 524288
  s_mov_b32 s7, 0x20000
  s_add_u32 s8, s40, s20
  s_addc_u32 s9, s41, 0
  s_mov_b32 s10, 524288
  s_mov_b32 s11, 0x20000
  s_and_b32 s25, s3, 3
  s_lshl_b32 s25, s25, 12
  s_waitcnt vmcnt(20)
  s_barrier
  s_xor_b32 s20, 0, s29
  s_lshl_b32 s20, s20, 14
  s_add_u32 m0, s25, 0
  s_add_u32 s20, s20, s25
  buffer_load_dwordx4 v3, s[4:7], s20 offen lds
  buffer_load_dwordx4 v3, s[4:7], s20 offen offset:1024 lds
  buffer_load_dwordx4 v4, s[4:7], s20 offen offset:2048 lds
  buffer_load_dwordx4 v4, s[4:7], s20 offen offset:3072 lds
  s_add_u32 m0, m0, 16384
  s_nop 0
  buffer_load_dwordx4 v3, s[8:11], s20 offen lds
  buffer_load_dwordx4 v3, s[8:11], s20 offen offset:1024 lds
  buffer_load_dwordx4 v4, s[8:11], s20 offen offset:2048 lds
  buffer_load_dwordx4 v4, s[8:11], s20 offen offset:3072 lds
  s_waitcnt vmcnt(18)
  s_barrier
  s_waitcnt vmcnt(8)
  s_barrier
  s_and_b32 s68, s3, 1
  s_lshr_b32 s67, s3, 1
  s_lshl_b32 s32, s35, 16
  s_and_b32 s24, s67, 1
  s_lshl_b32 s24, s24, 13
  v_lshrrev_b32 v5, 4, v0
  v_and_b32 v6, 15, v0
  v_lshrrev_b32 v7, 2, v6
  v_and_b32 v8, 3, v6
  v_lshl_add_u32 v8, v7, 3, v8
  v_and_b32 v9, 7, v6
  v_lshlrev_b32 v9, 1, v9
  v_xor_b32 v9, v9, v5
  v_lshlrev_b32 v9, 4, v9
  v_lshl_add_u32 v9, v8, 8, v9
  v_add_u32 v1, s24, v9
  v_and_b32 v8, 1, v5
  v_lshl_or_b32 v8, v8, 2, v7
  s_lshl_b32 s20, s67, 1
  v_xor_b32 v8, s20, v8
  v_lshlrev_b32 v8, 5, v8
  v_lshl_add_u32 v7, v5, 3, v7
  v_lshl_add_u32 v8, v7, 8, v8
  v_and_b32 v9, 3, v0
  v_lshl_add_u32 v8, v9, 3, v8
  v_add_u32 v2, s24, v8
  v_mov_b64 v[20:21], 0
  v_mov_b64 v[22:23], 0
  v_mov_b64 v[24:25], 0
  v_mov_b64 v[26:27], 0
  v_mov_b64 v[28:29], 0
  v_mov_b64 v[30:31], 0
  s_mov_b32 s69, 0xff800000
  s_mov_b32 s70, 0xff800000
  s_mov_b32 s87, 0
  v_add_u32 v248, s32, v1
  v_xor_b32 v249, 64, v248
  v_xor_b32 v250, 128, v248
  v_xor_b32 v251, 192, v248
  v_add_u32 v8, s32, v2
  v_xor_b32 v9, 32, v8
  v_xor_b32 v10, 64, v8
  v_xor_b32 v11, 96, v8
  v_xor_b32 v12, 128, v8
  v_xor_b32 v13, 160, v8
  v_xor_b32 v14, 192, v8
  v_xor_b32 v15, 224, v8
  s_add_u32 s33, s35, 4
  s_mov_b32 s28, 0
  s_barrier
  s_xor_b32 s20, 1, s29
  s_lshl_b32 s20, s20, 14
  s_add_u32 m0, s25, 65536
  s_add_u32 s20, s20, s25
  buffer_load_dwordx4 v3, s[4:7], s20 offen lds
  buffer_load_dwordx4 v3, s[4:7], s20 offen offset:1024 lds
  buffer_load_dwordx4 v4, s[4:7], s20 offen offset:2048 lds
  buffer_load_dwordx4 v4, s[4:7], s20 offen offset:3072 lds
  s_add_u32 m0, m0, 16384
  s_nop 0
  buffer_load_dwordx4 v3, s[8:11], s20 offen lds
  buffer_load_dwordx4 v3, s[8:11], s20 offen offset:1024 lds
  buffer_load_dwordx4 v4, s[8:11], s20 offen offset:2048 lds
  buffer_load_dwordx4 v4, s[8:11], s20 offen offset:3072 lds
  v_mov_b32 v16, 0x3f803f80
  v_mov_b32 v17, 0x3f803f80
  v_mov_b32 v18, 0x3f803f80
  v_mov_b32 v19, 0x3f803f80
  v_mov_b64 v[32:33], 0
  v_mov_b64 v[34:35], 0
  v_mov_b64 v[36:37], 0
  v_mov_b64 v[38:39], 0
  v_mov_b64 v[40:41], 0
  v_mov_b64 v[42:43], 0
  v_mov_b64 v[152:153], 0
  v_mov_b64 v[154:155], 0
  v_mov_b64 v[156:157], 0
  v_mov_b64 v[158:159], 0
  v_mov_b64 v[160:161], 0
  v_mov_b64 v[162:163], 0
  v_mov_b64 v[164:165], 0
  v_mov_b64 v[166:167], 0
  v_mov_b64 v[168:169], 0
  v_mov_b64 v[170:171], 0
  v_mov_b64 v[172:173], 0
  v_mov_b64 v[174:175], 0
  v_mov_b64 v[176:177], 0
  v_mov_b64 v[178:179], 0
  v_mov_b64 v[180:181], 0
  v_mov_b64 v[182:183], 0
  v_mov_b64 v[184:185], 0
  v_mov_b64 v[186:187], 0
  v_mov_b64 v[188:189], 0
  v_mov_b64 v[190:191], 0
  v_mov_b64 v[192:193], 0
  v_mov_b64 v[194:195], 0
  v_mov_b64 v[196:197], 0
  v_mov_b64 v[198:199], 0
  v_mov_b64 v[200:201], 0
  v_mov_b64 v[202:203], 0
  v_mov_b64 v[204:205], 0
  v_mov_b64 v[206:207], 0
  v_mov_b64 v[208:209], 0
  v_mov_b64 v[210:211], 0
  v_mov_b64 v[212:213], 0
  v_mov_b64 v[214:215], 0
  v_mov_b64 v[216:217], 0
  v_mov_b64 v[218:219], 0
  v_mov_b64 v[220:221], 0
  v_mov_b64 v[222:223], 0
  v_mov_b64 v[224:225], 0
  v_mov_b64 v[226:227], 0
  v_mov_b64 v[228:229], 0
  v_mov_b64 v[230:231], 0
  v_mov_b64 v[232:233], 0
  v_mov_b64 v[234:235], 0
  v_mov_b64 v[236:237], 0
  v_mov_b64 v[238:239], 0
  v_mov_b64 v[240:241], 0
  v_mov_b64 v[242:243], 0
  v_mov_b64 v[244:245], 0
  v_mov_b64 v[246:247], 0
  s_xor_b32 s20, 2, s29
  s_lshl_b32 s20, s20, 14
  s_add_u32 m0, s25, 32768
  s_add_u32 s20, s20, s25
  buffer_load_dwordx4 v3, s[4:7], s20 offen lds
  buffer_load_dwordx4 v3, s[4:7], s20 offen offset:1024 lds
  buffer_load_dwordx4 v4, s[4:7], s20 offen offset:2048 lds
  buffer_load_dwordx4 v4, s[4:7], s20 offen offset:3072 lds
  s_add_u32 m0, m0, 16384
  s_nop 0
  buffer_load_dwordx4 v3, s[8:11], s20 offen lds
  buffer_load_dwordx4 v3, s[8:11], s20 offen offset:1024 lds
  buffer_load_dwordx4 v4, s[8:11], s20 offen offset:2048 lds
  buffer_load_dwordx4 v4, s[8:11], s20 offen offset:3072 lds
  s_waitcnt vmcnt(16)
  s_branch L_q_done
L_qa_w:
  s_cmp_eq_u32 s33, 2
  s_cbranch_scc1 L_qa_wk
  s_cmp_eq_u32 s33, 1
  s_cbranch_scc0 L_qa_w0
  s_waitcnt vmcnt(17)
  s_barrier
  s_waitcnt vmcnt(10)
  s_branch L_qa_wj
L_qa_w0:
  s_waitcnt vmcnt(14)
  s_branch L_qa_wj
L_q_comp:
  v_lshrrev_b32 v7, 2, v6
  v_and_b32 v22, 1, v5
  v_lshl_or_b32 v22, v22, 2, v7
  s_and_b32 s20, s3, 1
  s_lshl_b32 s20, s20, 2
  v_xor_b32 v22, s20, v22
  v_lshlrev_b32 v22, 5, v22
  v_lshl_add_u32 v7, v5, 3, v7
  v_lshl_add_u32 v22, v7, 8, v22
  v_and_b32 v23, 3, v0
  v_lshl_add_u32 v8, v23, 3, v22
  v_xor_b32 v9, 32, v8
  v_xor_b32 v10, 64, v8
  v_xor_b32 v11, 96, v8
  v_add_u32 v12, 81920, v8
  v_add_u32 v13, 81920, v9
  v_add_u32 v14, 81920, v10
  v_add_u32 v15, 81920, v11
  v_and_b32 v22, 6, v6
  v_xor_b32 v7, v5, v22
  v_lshlrev_b32 v7, 4, v7
  v_lshl_add_u32 v7, v6, 7, v7
  s_lshr_b32 s22, s3, 1
  s_mul_i32 s21, s22, 6144
  s_add_u32 s21, s21, 16384
  v_add_u32 v16, s21, v7
  v_xor_b32 v17, 64, v16
  v_add_u32 v18, 81920, v16
  v_add_u32 v19, 81920, v17
  v_lshrrev_b32 v22, 5, v0
  v_lshlrev_b32 v22, 8, v22
  v_lshl_add_u32 v22, v6, 4, v22
  v_bfe_u32 v23, v0, 4, 1
  v_lshl_add_u32 v22, v23, 9, v22
  v_and_b32 v20, 7, v0
  v_lshlrev_b32 v20, 2, v20
  v_mov_b32 v21, 0
  v_mov_b64 v[184:185], 0
  v_mov_b64 v[186:187], 0
  v_mov_b64 v[188:189], 0
  v_mov_b64 v[190:191], 0
  v_mov_b64 v[192:193], 0
  v_mov_b64 v[194:195], 0
  v_mov_b64 v[196:197], 0
  v_mov_b64 v[198:199], 0
  v_mov_b64 v[200:201], 0
  v_mov_b64 v[202:203], 0
  v_mov_b64 v[204:205], 0
  v_mov_b64 v[206:207], 0
  v_mov_b64 v[208:209], 0
  v_mov_b64 v[210:211], 0
  v_mov_b64 v[212:213], 0
  v_mov_b64 v[214:215], 0
  v_mov_b64 v[216:217], 0
  v_mov_b64 v[218:219], 0
  v_mov_b64 v[220:221], 0
  v_mov_b64 v[222:223], 0
  v_mov_b64 v[224:225], 0
  v_mov_b64 v[226:227], 0
  v_mov_b64 v[228:229], 0
  v_mov_b64 v[230:231], 0
  v_mov_b64 v[232:233], 0
  v_mov_b64 v[234:235], 0
  v_mov_b64 v[236:237], 0
  v_mov_b64 v[238:239], 0
  v_mov_b64 v[240:241], 0
  v_mov_b64 v[242:243], 0
  v_mov_b64 v[244:245], 0
  v_mov_b64 v[246:247], 0
  v_lshrrev_b32 v5, 4, v0
  v_and_b32 v6, 15, v0
  v_lshlrev_b32 v7, 1, v5
  v_xor_b32 v7, v7, v6
  v_lshlrev_b32 v7, 4, v7
  v_lshl_add_u32 v3, v5, 8, v7
  v_xor_b32 v4, 128, v3
  s_waitcnt lgkmcnt(0)
  s_mov_b32 s12, s60
  s_mov_b32 s13, s61
  s_mov_b32 s14, 17170432
  s_mov_b32 s15, 0x20000
  s_mov_b32 s16, s58
  s_mov_b32 s17, s59
  s_mov_b32 s18, 256
  s_mov_b32 s19, 0x20000
  s_and_b32 s29, s63, 3
  s_lshl_b32 s20, s81, 2
  s_or_b32 s29, s29, s20
  s_lshr_b32 s21, s62, 1
  s_add_u32 s20, s20, s21
  s_lshl_b32 s20, s20, 19
  s_add_u32 s4, s38, s20
  s_addc_u32 s5, s39, 0
  s_mov_b32 s6, 524288
  s_mov_b32 s7, 0x20000
  s_add_u32 s8, s40, s20
  s_addc_u32 s9, s41, 0
  s_mov_b32 s10, 524288
  s_mov_b32 s11, 0x20000
  s_and_b32 s25, s3, 3
  s_lshl_b32 s25, s25, 12
  s_mov_b32 s80, 1
L_q_side:
  v_mov_b64 v[24:25], 0
  v_mov_b64 v[26:27], 0
  v_mov_b64 v[28:29], 0
  v_mov_b64 v[30:31], 0
  v_mov_b64 v[32:33], 0
  v_mov_b64 v[34:35], 0
  v_mov_b64 v[36:37], 0
  v_mov_b64 v[38:39], 0
  v_mov_b64 v[40:41], 0
  v_mov_b64 v[42:43], 0
  v_mov_b64 v[44:45], 0
  v_mov_b64 v[46:47], 0
  v_mov_b64 v[48:49], 0
  v_mov_b64 v[50:51], 0
  v_mov_b64 v[52:53], 0
  v_mov_b64 v[54:55], 0
  v_mov_b64 v[56:57], 0
  v_mov_b64 v[58:59], 0
  v_mov_b64 v[60:61], 0
  v_mov_b64 v[62:63], 0
  v_mov_b64 v[64:65], 0
  v_mov_b64 v[66:67], 0
  v_mov_b64 v[68:69], 0
  v_mov_b64 v[70:71], 0
  s_mov_b32 s28, 0
  s_barrier
  ds_read_b128 v[88:91], v16 offset:0
  ds_read_b128 v[92:95], v16 offset:2048
  ds_read_b128 v[96:99], v16 offset:4096
  ds_read_b64_tr_b16 v[72:73], v8 offset:0
  ds_read_b64_tr_b16 v[74:75], v8 offset:1024
  ds_read_b64_tr_b16 v[76:77], v9 offset:0
  ds_read_b64_tr_b16 v[78:79], v9 offset:1024
  ds_read_b64_tr_b16 v[80:81], v10 offset:0
  ds_read_b64_tr_b16 v[82:83], v10 offset:1024
  ds_read_b64_tr_b16 v[84:85], v11 offset:0
  ds_read_b64_tr_b16 v[86:87], v11 offset:1024
  ds_read_b128 v[116:119], v17 offset:0
  ds_read_b128 v[120:123], v17 offset:2048
  ds_read_b128 v[124:127], v17 offset:4096
  ds_read_b64_tr_b16 v[100:101], v8 offset:8192
  ds_read_b64_tr_b16 v[102:103], v8 offset:9216
  ds_read_b64_tr_b16 v[104:105], v9 offset:8192
  ds_read_b64_tr_b16 v[106:107], v9 offset:9216
  ds_read_b64_tr_b16 v[108:109], v10 offset:8192
  ds_read_b64_tr_b16 v[110:111], v10 offset:9216
  ds_read_b64_tr_b16 v[112:113], v11 offset:8192
  ds_read_b64_tr_b16 v[114:115], v11 offset:9216
  s_branch L_q_in
L_q_loop:
  s_barrier
  ds_read_b128 v[88:91], v16 offset:0
  ds_read_b128 v[92:95], v16 offset:2048
  v_mfma_f32_16x16x32_bf16 v[24:27], v[128:131], v[144:147], v[24:27]
  ds_read_b128 v[96:99], v16 offset:4096
  ds_read_b64_tr_b16 v[72:73], v8 offset:0
  v_mfma_f32_16x16x32_bf16 v[28:31], v[128:131], v[148:151], v[28:31]
  ds_read_b64_tr_b16 v[74:75], v8 offset:1024
  ds_read_b64_tr_b16 v[76:77], v9 offset:0
  v_mfma_f32_16x16x32_bf16 v[32:35], v[128:131], v[152:155], v[32:35]
  ds_read_b64_tr_b16 v[78:79], v9 offset:1024
  ds_read_b64_tr_b16 v[80:81], v10 offset:0
  v_mfma_f32_16x16x32_bf16 v[36:39], v[132:135], v[144:147], v[36:39]
  ds_read_b64_tr_b16 v[82:83], v10 offset:1024
  v_mfma_f32_16x16x32_bf16 v[40:43], v[132:135], v[148:151], v[40:43]
  ds_read_b64_tr_b16 v[84:85], v11 offset:0
  v_mfma_f32_16x16x32_bf16 v[44:47], v[132:135], v[152:155], v[44:47]
  ds_read_b64_tr_b16 v[86:87], v11 offset:1024
  v_mfma_f32_16x16x32_bf16 v[48:51], v[136:139], v[144:147], v[48:51]
  ds_read_b128 v[116:119], v17 offset:0
  v_mfma_f32_16x16x32_bf16 v[52:55], v[136:139], v[148:151], v[52:55]
  ds_read_b128 v[120:123], v17 offset:2048
  v_mfma_f32_16x16x32_bf16 v[56:59], v[136:139], v[152:155], v[56:59]
  ds_read_b128 v[124:127], v17 offset:4096
  v_mfma_f32_16x16x32_bf16 v[60:63], v[140:143], v[144:147], v[60:63]
  ds_read_b64_tr_b16 v[100:101], v8 offset:8192
  v_mfma_f32_16x16x32_bf16 v[64:67], v[140:143], v[148:151], v[64:67]
  ds_read_b64_tr_b16 v[102:103], v8 offset:9216
  v_mfma_f32_16x16x32_bf16 v[68:71], v[140:143], v[152:155], v[68:71]
  ds_read_b64_tr_b16 v[104:105], v9 offset:8192
  v_mfma_f32_16x16x32_bf16 v[24:27], v[156:159], v[172:175], v[24:27]
  ds_read_b64_tr_b16 v[106:107], v9 offset:9216
  v_mfma_f32_16x16x32_bf16 v[28:31], v[156:159], v[176:179], v[28:31]
  ds_read_b64_tr_b16 v[108:109], v10 offset:8192
  v_mfma_f32_16x16x32_bf16 v[32:35], v[156:159], v[180:183], v[32:35]
  ds_read_b64_tr_b16 v[110:111], v10 offset:9216
  v_mfma_f32_16x16x32_bf16 v[36:39], v[160:163], v[172:175], v[36:39]
  ds_read_b64_tr_b16 v[112:113], v11 offset:8192
  v_mfma_f32_16x16x32_bf16 v[40:43], v[160:163], v[176:179], v[40:43]
  ds_read_b64_tr_b16 v[114:115], v11 offset:9216
  v_mfma_f32_16x16x32_bf16 v[44:47], v[160:163], v[180:183], v[44:47]
  v_mfma_f32_16x16x32_bf16 v[48:51], v[164:167], v[172:175], v[48:51]
  v_mfma_f32_16x16x32_bf16 v[52:55], v[164:167], v[176:179], v[52:55]
  v_mfma_f32_16x16x32_bf16 v[56:59], v[164:167], v[180:183], v[56:59]
  v_mfma_f32_16x16x32_bf16 v[60:63], v[168:171], v[172:175], v[60:63]
  v_mfma_f32_16x16x32_bf16 v[64:67], v[168:171], v[176:179], v[64:67]
  v_mfma_f32_16x16x32_bf16 v[68:71], v[168:171], v[180:183], v[68:71]
L_q_in:
  s_waitcnt lgkmcnt(0)
  s_barrier
  ds_read_b128 v[144:147], v16 offset:40960
  ds_read_b128 v[148:151], v16 offset:43008
  v_mfma_f32_16x16x32_bf16 v[24:27], v[72:75], v[88:91], v[24:27]
  ds_read_b128 v[152:155], v16 offset:45056
  ds_read_b64_tr_b16 v[128:129], v8 offset:40960
  v_mfma_f32_16x16x32_bf16 v[28:31], v[72:75], v[92:95], v[28:31]
  ds_read_b64_tr_b16 v[130:131], v8 offset:41984
  ds_read_b64_tr_b16 v[132:133], v9 offset:40960
  v_mfma_f32_16x16x32_bf16 v[32:35], v[72:75], v[96:99], v[32:35]
  ds_read_b64_tr_b16 v[134:135], v9 offset:41984
  ds_read_b64_tr_b16 v[136:137], v10 offset:40960
  v_mfma_f32_16x16x32_bf16 v[36:39], v[76:79], v[88:91], v[36:39]
  ds_read_b64_tr_b16 v[138:139], v10 offset:41984
  v_mfma_f32_16x16x32_bf16 v[40:43], v[76:79], v[92:95], v[40:43]
  ds_read_b64_tr_b16 v[140:141], v11 offset:40960
  v_mfma_f32_16x16x32_bf16 v[44:47], v[76:79], v[96:99], v[44:47]
  ds_read_b64_tr_b16 v[142:143], v11 offset:41984
  v_mfma_f32_16x16x32_bf16 v[48:51], v[80:83], v[88:91], v[48:51]
  ds_read_b128 v[172:175], v17 offset:40960
  v_mfma_f32_16x16x32_bf16 v[52:55], v[80:83], v[92:95], v[52:55]
  ds_read_b128 v[176:179], v17 offset:43008
  v_mfma_f32_16x16x32_bf16 v[56:59], v[80:83], v[96:99], v[56:59]
  ds_read_b128 v[180:183], v17 offset:45056
  v_mfma_f32_16x16x32_bf16 v[60:63], v[84:87], v[88:91], v[60:63]
  ds_read_b64_tr_b16 v[156:157], v8 offset:49152
  v_mfma_f32_16x16x32_bf16 v[64:67], v[84:87], v[92:95], v[64:67]
  ds_read_b64_tr_b16 v[158:159], v8 offset:50176
  v_mfma_f32_16x16x32_bf16 v[68:71], v[84:87], v[96:99], v[68:71]
  ds_read_b64_tr_b16 v[160:161], v9 offset:49152
  v_mfma_f32_16x16x32_bf16 v[24:27], v[100:103], v[116:119], v[24:27]
  ds_read_b64_tr_b16 v[162:163], v9 offset:50176
  v_mfma_f32_16x16x32_bf16 v[28:31], v[100:103], v[120:123], v[28:31]
  ds_read_b64_tr_b16 v[164:165], v10 offset:49152
  v_mfma_f32_16x16x32_bf16 v[32:35], v[100:103], v[124:127], v[32:35]
  ds_read_b64_tr_b16 v[166:167], v10 offset:50176
  v_mfma_f32_16x16x32_bf16 v[36:39], v[104:107], v[116:119], v[36:39]
  ds_read_b64_tr_b16 v[168:169], v11 offset:49152
  v_mfma_f32_16x16x32_bf16 v[40:43], v[104:107], v[120:123], v[40:43]
  ds_read_b64_tr_b16 v[170:171], v11 offset:50176
  v_mfma_f32_16x16x32_bf16 v[44:47], v[104:107], v[124:127], v[44:47]
  v_mfma_f32_16x16x32_bf16 v[48:51], v[108:111], v[116:119], v[48:51]
  v_mfma_f32_16x16x32_bf16 v[52:55], v[108:111], v[120:123], v[52:55]
  v_mfma_f32_16x16x32_bf16 v[56:59], v[108:111], v[124:127], v[56:59]
  v_mfma_f32_16x16x32_bf16 v[60:63], v[112:115], v[116:119], v[60:63]
  v_mfma_f32_16x16x32_bf16 v[64:67], v[112:115], v[120:123], v[64:67]
  v_mfma_f32_16x16x32_bf16 v[68:71], v[112:115], v[124:127], v[68:71]
  s_or_b32 s20, s28, s80
  s_cbranch_scc1 L_q_ns
  s_lshl_b32 s20, s65, 2
  s_add_u32 s20, s20, s3
  s_lshl_b32 s20, s20, 7
  s_add_u32 s20, s20, 12779520
  s_waitcnt vmcnt(0)
  v_mov_b32 v21, 1
  s_mov_b64 exec, 1
  buffer_store_dword v21, v20, s[12:15], s20 offen sc1
  s_mov_b64 exec, -1
L_q_ns:
  s_waitcnt lgkmcnt(0)
  s_barrier
  ds_read_b128 v[88:91], v18 offset:0
  ds_read_b128 v[92:95], v18 offset:2048
  v_mfma_f32_16x16x32_bf16 v[24:27], v[128:131], v[144:147], v[24:27]
  ds_read_b128 v[96:99], v18 offset:4096
  ds_read_b64_tr_b16 v[72:73], v12 offset:0
  v_mfma_f32_16x16x32_bf16 v[28:31], v[128:131], v[148:151], v[28:31]
  ds_read_b64_tr_b16 v[74:75], v12 offset:1024
  ds_read_b64_tr_b16 v[76:77], v13 offset:0
  v_mfma_f32_16x16x32_bf16 v[32:35], v[128:131], v[152:155], v[32:35]
  ds_read_b64_tr_b16 v[78:79], v13 offset:1024
  ds_read_b64_tr_b16 v[80:81], v14 offset:0
  v_mfma_f32_16x16x32_bf16 v[36:39], v[132:135], v[144:147], v[36:39]
  ds_read_b64_tr_b16 v[82:83], v14 offset:1024
  v_mfma_f32_16x16x32_bf16 v[40:43], v[132:135], v[148:151], v[40:43]
  ds_read_b64_tr_b16 v[84:85], v15 offset:0
  v_mfma_f32_16x16x32_bf16 v[44:47], v[132:135], v[152:155], v[44:47]
  ds_read_b64_tr_b16 v[86:87], v15 offset:1024
  v_mfma_f32_16x16x32_bf16 v[48:51], v[136:139], v[144:147], v[48:51]
  ds_read_b128 v[116:119], v19 offset:0
  v_mfma_f32_16x16x32_bf16 v[52:55], v[136:139], v[148:151], v[52:55]
  ds_read_b128 v[120:123], v19 offset:2048
  v_mfma_f32_16x16x32_bf16 v[56:59], v[136:139], v[152:155], v[56:59]
  ds_read_b128 v[124:127], v19 offset:4096
  v_mfma_f32_16x16x32_bf16 v[60:63], v[140:143], v[144:147], v[60:63]
  ds_read_b64_tr_b16 v[100:101], v12 offset:8192
  v_mfma_f32_16x16x32_bf16 v[64:67], v[140:143], v[148:151], v[64:67]
  ds_read_b64_tr_b16 v[102:103], v12 offset:9216
  v_mfma_f32_16x16x32_bf16 v[68:71], v[140:143], v[152:155], v[68:71]
  ds_read_b64_tr_b16 v[104:105], v13 offset:8192
  v_mfma_f32_16x16x32_bf16 v[24:27], v[156:159], v[172:175], v[24:27]
  ds_read_b64_tr_b16 v[106:107], v13 offset:9216
  v_mfma_f32_16x16x32_bf16 v[28:31], v[156:159], v[176:179], v[28:31]
  ds_read_b64_tr_b16 v[108:109], v14 offset:8192
  v_mfma_f32_16x16x32_bf16 v[32:35], v[156:159], v[180:183], v[32:35]
  ds_read_b64_tr_b16 v[110:111], v14 offset:9216
  v_mfma_f32_16x16x32_bf16 v[36:39], v[160:163], v[172:175], v[36:39]
  ds_read_b64_tr_b16 v[112:113], v15 offset:8192
  v_mfma_f32_16x16x32_bf16 v[40:43], v[160:163], v[176:179], v[40:43]
  ds_read_b64_tr_b16 v[114:115], v15 offset:9216
  v_mfma_f32_16x16x32_bf16 v[44:47], v[160:163], v[180:183], v[44:47]
  v_mfma_f32_16x16x32_bf16 v[48:51], v[164:167], v[172:175], v[48:51]
  v_mfma_f32_16x16x32_bf16 v[52:55], v[164:167], v[176:179], v[52:55]
  v_mfma_f32_16x16x32_bf16 v[56:59], v[164:167], v[180:183], v[56:59]
  v_mfma_f32_16x16x32_bf16 v[60:63], v[168:171], v[172:175], v[60:63]
  v_mfma_f32_16x16x32_bf16 v[64:67], v[168:171], v[176:179], v[64:67]
  v_mfma_f32_16x16x32_bf16 v[68:71], v[168:171], v[180:183], v[68:71]
  s_waitcnt lgkmcnt(0)
  s_barrier
  ds_read_b128 v[144:147], v18 offset:40960
  ds_read_b128 v[148:151], v18 offset:43008
  v_mfma_f32_16x16x32_bf16 v[24:27], v[72:75], v[88:91], v[24:27]
  ds_read_b128 v[152:155], v18 offset:45056
  ds_read_b64_tr_b16 v[128:129], v12 offset:40960
  v_mfma_f32_16x16x32_bf16 v[28:31], v[72:75], v[92:95], v[28:31]
  ds_read_b64_tr_b16 v[130:131], v12 offset:41984
  ds_read_b64_tr_b16 v[132:133], v13 offset:40960
  v_mfma_f32_16x16x32_bf16 v[32:35], v[72:75], v[96:99], v[32:35]
  ds_read_b64_tr_b16 v[134:135], v13 offset:41984
  ds_read_b64_tr_b16 v[136:137], v14 offset:40960
  v_mfma_f32_16x16x32_bf16 v[36:39], v[76:79], v[88:91], v[36:39]
  ds_read_b64_tr_b16 v[138:139], v14 offset:41984
  v_mfma_f32_16x16x32_bf16 v[40:43], v[76:79], v[92:95], v[40:43]
  ds_read_b64_tr_b16 v[140:141], v15 offset:40960
  v_mfma_f32_16x16x32_bf16 v[44:47], v[76:79], v[96:99], v[44:47]
  ds_read_b64_tr_b16 v[142:143], v15 offset:41984
  v_mfma_f32_16x16x32_bf16 v[48:51], v[80:83], v[88:91], v[48:51]
  ds_read_b128 v[172:175], v19 offset:40960
  v_mfma_f32_16x16x32_bf16 v[52:55], v[80:83], v[92:95], v[52:55]
  ds_read_b128 v[176:179], v19 offset:43008
  v_mfma_f32_16x16x32_bf16 v[56:59], v[80:83], v[96:99], v[56:59]
  ds_read_b128 v[180:183], v19 offset:45056
  v_mfma_f32_16x16x32_bf16 v[60:63], v[84:87], v[88:91], v[60:63]
  ds_read_b64_tr_b16 v[156:157], v12 offset:49152
  v_mfma_f32_16x16x32_bf16 v[64:67], v[84:87], v[92:95], v[64:67]
  ds_read_b64_tr_b16 v[158:159], v12 offset:50176
  v_mfma_f32_16x16x32_bf16 v[68:71], v[84:87], v[96:99], v[68:71]
  ds_read_b64_tr_b16 v[160:161], v13 offset:49152
  v_mfma_f32_16x16x32_bf16 v[24:27], v[100:103], v[116:119], v[24:27]
  ds_read_b64_tr_b16 v[162:163], v13 offset:50176
  v_mfma_f32_16x16x32_bf16 v[28:31], v[100:103], v[120:123], v[28:31]
  ds_read_b64_tr_b16 v[164:165], v14 offset:49152
  v_mfma_f32_16x16x32_bf16 v[32:35], v[100:103], v[124:127], v[32:35]
  ds_read_b64_tr_b16 v[166:167], v14 offset:50176
  v_mfma_f32_16x16x32_bf16 v[36:39], v[104:107], v[116:119], v[36:39]
  ds_read_b64_tr_b16 v[168:169], v15 offset:49152
  v_mfma_f32_16x16x32_bf16 v[40:43], v[104:107], v[120:123], v[40:43]
  ds_read_b64_tr_b16 v[170:171], v15 offset:50176
  v_mfma_f32_16x16x32_bf16 v[44:47], v[104:107], v[124:127], v[44:47]
  v_mfma_f32_16x16x32_bf16 v[48:51], v[108:111], v[116:119], v[48:51]
  v_mfma_f32_16x16x32_bf16 v[52:55], v[108:111], v[120:123], v[52:55]
  v_mfma_f32_16x16x32_bf16 v[56:59], v[108:111], v[124:127], v[56:59]
  v_mfma_f32_16x16x32_bf16 v[60:63], v[112:115], v[116:119], v[60:63]
  v_mfma_f32_16x16x32_bf16 v[64:67], v[112:115], v[120:123], v[64:67]
  v_mfma_f32_16x16x32_bf16 v[68:71], v[112:115], v[124:127], v[68:71]
  s_waitcnt lgkmcnt(0)
  s_add_u32 s28, s28, 1
  s_mul_i32 s20, s28, s80
  s_cmp_eq_u32 s20, 3
  s_cbranch_scc0 L_q_nf
  buffer_load_dword v21, v20, s[16:19], 0 offen sc1
L_q_nf:
  s_cmp_lt_u32 s28, 4
  s_cbranch_scc1 L_q_loop
  s_cmp_eq_u32 s80, 0
  s_cbranch_scc0 L_q_nb
  s_barrier
L_q_nb:
  v_mfma_f32_16x16x32_bf16 v[24:27], v[128:131], v[144:147], v[24:27]
  v_mfma_f32_16x16x32_bf16 v[28:31], v[128:131], v[148:151], v[28:31]
  v_mfma_f32_16x16x32_bf16 v[32:35], v[128:131], v[152:155], v[32:35]
  v_mfma_f32_16x16x32_bf16 v[36:39], v[132:135], v[144:147], v[36:39]
  v_mfma_f32_16x16x32_bf16 v[40:43], v[132:135], v[148:151], v[40:43]
  v_mfma_f32_16x16x32_bf16 v[44:47], v[132:135], v[152:155], v[44:47]
  v_mfma_f32_16x16x32_bf16 v[48:51], v[136:139], v[144:147], v[48:51]
  v_mfma_f32_16x16x32_bf16 v[52:55], v[136:139], v[148:151], v[52:55]
  v_mfma_f32_16x16x32_bf16 v[56:59], v[136:139], v[152:155], v[56:59]
  v_mfma_f32_16x16x32_bf16 v[60:63], v[140:143], v[144:147], v[60:63]
  v_mfma_f32_16x16x32_bf16 v[64:67], v[140:143], v[148:151], v[64:67]
  v_mfma_f32_16x16x32_bf16 v[68:71], v[140:143], v[152:155], v[68:71]
  v_mfma_f32_16x16x32_bf16 v[24:27], v[156:159], v[172:175], v[24:27]
  v_mfma_f32_16x16x32_bf16 v[28:31], v[156:159], v[176:179], v[28:31]
  v_mfma_f32_16x16x32_bf16 v[32:35], v[156:159], v[180:183], v[32:35]
  v_mfma_f32_16x16x32_bf16 v[36:39], v[160:163], v[172:175], v[36:39]
  v_mfma_f32_16x16x32_bf16 v[40:43], v[160:163], v[176:179], v[40:43]
  v_mfma_f32_16x16x32_bf16 v[44:47], v[160:163], v[180:183], v[44:47]
  v_mfma_f32_16x16x32_bf16 v[48:51], v[164:167], v[172:175], v[48:51]
  v_mfma_f32_16x16x32_bf16 v[52:55], v[164:167], v[176:179], v[52:55]
  v_mfma_f32_16x16x32_bf16 v[56:59], v[164:167], v[180:183], v[56:59]
  v_mfma_f32_16x16x32_bf16 v[60:63], v[168:171], v[172:175], v[60:63]
  v_mfma_f32_16x16x32_bf16 v[64:67], v[168:171], v[176:179], v[64:67]
  v_mfma_f32_16x16x32_bf16 v[68:71], v[168:171], v[180:183], v[68:71]
  v_mul_f32 v24, 0x3e0293ee, v24
  v_mul_f32 v25, 0x3e0293ee, v25
  v_mul_f32 v26, 0x3e0293ee, v26
  v_mul_f32 v27, 0x3e0293ee, v27
  v_cvt_pk_bf16_f32 v72, v24, v25
  v_cvt_pk_bf16_f32 v73, v26, v27
  v_mul_f32 v28, 0x3e0293ee, v28
  v_mul_f32 v29, 0x3e0293ee, v29
  v_mul_f32 v30, 0x3e0293ee, v30
  v_mul_f32 v31, 0x3e0293ee, v31
  v_cvt_pk_bf16_f32 v76, v28, v29
  v_cvt_pk_bf16_f32 v77, v30, v31
  v_mul_f32 v32, 0x3e0293ee, v32
  v_mul_f32 v33, 0x3e0293ee, v33
  v_mul_f32 v34, 0x3e0293ee, v34
  v_mul_f32 v35, 0x3e0293ee, v35
  v_cvt_pk_bf16_f32 v80, v32, v33
  v_cvt_pk_bf16_f32 v81, v34, v35
  v_mul_f32 v36, 0x3e0293ee, v36
  v_mul_f32 v37, 0x3e0293ee, v37
  v_mul_f32 v38, 0x3e0293ee, v38
  v_mul_f32 v39, 0x3e0293ee, v39
  v_cvt_pk_bf16_f32 v74, v36, v37
  v_cvt_pk_bf16_f32 v75, v38, v39
  v_mul_f32 v40, 0x3e0293ee, v40
  v_mul_f32 v41, 0x3e0293ee, v41
  v_mul_f32 v42, 0x3e0293ee, v42
  v_mul_f32 v43, 0x3e0293ee, v43
  v_cvt_pk_bf16_f32 v78, v40, v41
  v_cvt_pk_bf16_f32 v79, v42, v43
  v_mul_f32 v44, 0x3e0293ee, v44
  v_mul_f32 v45, 0x3e0293ee, v45
  v_mul_f32 v46, 0x3e0293ee, v46
  v_mul_f32 v47, 0x3e0293ee, v47
  v_cvt_pk_bf16_f32 v82, v44, v45
  v_cvt_pk_bf16_f32 v83, v46, v47
  v_mul_f32 v48, 0x3e0293ee, v48
  v_mul_f32 v49, 0x3e0293ee, v49
  v_mul_f32 v50, 0x3e0293ee, v50
  v_mul_f32 v51, 0x3e0293ee, v51
  v_cvt_pk_bf16_f32 v84, v48, v49
  v_cvt_pk_bf16_f32 v85, v50, v51
  v_mul_f32 v52, 0x3e0293ee, v52
  v_mul_f32 v53, 0x3e0293ee, v53
  v_mul_f32 v54, 0x3e0293ee, v54
  v_mul_f32 v55, 0x3e0293ee, v55
  v_cvt_pk_bf16_f32 v88, v52, v53
  v_cvt_pk_bf16_f32 v89, v54, v55
  v_mul_f32 v56, 0x3e0293ee, v56
  v_mul_f32 v57, 0x3e0293ee, v57
  v_mul_f32 v58, 0x3e0293ee, v58
  v_mul_f32 v59, 0x3e0293ee, v59
  v_cvt_pk_bf16_f32 v92, v56, v57
  v_cvt_pk_bf16_f32 v93, v58, v59
  v_mul_f32 v60, 0x3e0293ee, v60
  v_mul_f32 v61, 0x3e0293ee, v61
  v_mul_f32 v62, 0x3e0293ee, v62
  v_mul_f32 v63, 0x3e0293ee, v63
  v_cvt_pk_bf16_f32 v86, v60, v61
  v_cvt_pk_bf16_f32 v87, v62, v63
  v_mul_f32 v64, 0x3e0293ee, v64
  v_mul_f32 v65, 0x3e0293ee, v65
  v_mul_f32 v66, 0x3e0293ee, v66
  v_mul_f32 v67, 0x3e0293ee, v67
  v_cvt_pk_bf16_f32 v90, v64, v65
  v_cvt_pk_bf16_f32 v91, v66, v67
  v_mul_f32 v68, 0x3e0293ee, v68
  v_mul_f32 v69, 0x3e0293ee, v69
  v_mul_f32 v70, 0x3e0293ee, v70
  v_mul_f32 v71, 0x3e0293ee, v71
  v_cvt_pk_bf16_f32 v94, v68, v69
  v_cvt_pk_bf16_f32 v95, v70, v71
  v_permlane16_swap_b32 v72, v74
  v_permlane16_swap_b32 v73, v75
  v_permlane16_swap_b32 v76, v78
  v_permlane16_swap_b32 v77, v79
  v_permlane16_swap_b32 v80, v82
  v_permlane16_swap_b32 v81, v83
  v_permlane16_swap_b32 v84, v86
  v_permlane16_swap_b32 v85, v87
  v_permlane16_swap_b32 v88, v90
  v_permlane16_swap_b32 v89, v91
  v_permlane16_swap_b32 v92, v94
  v_permlane16_swap_b32 v93, v95
  s_mul_i32 s21, s3, 6144
  s_cmp_eq_u32 s80, 0
  s_cbranch_scc1 L_q_own
  s_waitcnt vmcnt(0)
  v_cmp_ne_u32 vcc, 1, v21
  s_cbranch_vccz L_q_clr
  s_mov_b32 s71, 0
L_poll6:
  buffer_load_dword v21, v20, s[16:19], 0 offen sc1
  s_waitcnt vmcnt(0)
  v_cmp_ne_u32 vcc, 1, v21
  s_cbranch_vccz L_polld7
  s_sleep 32
  s_add_u32 s71, s71, 1
  s_cmp_lt_u32 s71, 0x20000
  s_cbranch_scc1 L_poll6
L_polld7:
L_q_clr:
  s_mul_i32 s20, s65, 24576
  s_add_u32 s20, s20, s21
  s_add_u32 s20, s20, 9437184
  buffer_store_dwordx4 v[72:75], v22, s[12:15], s20 offen offset:0 sc1
  buffer_store_dwordx4 v[76:79], v22, s[12:15], s20 offen offset:1024 sc1
  buffer_store_dwordx4 v[80:83], v22, s[12:15], s20 offen offset:2048 sc1
  s_add_u32 s20, s20, 3072
  buffer_store_dwordx4 v[84:87], v22, s[12:15], s20 offen offset:0 sc1
  buffer_store_dwordx4 v[88:91], v22, s[12:15], s20 offen offset:1024 sc1
  buffer_store_dwordx4 v[92:95], v22, s[12:15], s20 offen offset:2048 sc1
  s_lshl_b32 s20, s22, 14
  v_add_u32 v8, s20, v8
  v_add_u32 v9, s20, v9
  v_add_u32 v10, s20, v10
  v_add_u32 v11, s20, v11
  v_add_u32 v12, s20, v12
  v_add_u32 v13, s20, v13
  v_add_u32 v14, s20, v14
  v_add_u32 v15, s20, v15
  s_mul_i32 s20, s22, 6144
  s_sub_u32 s20, 16384, s20
  v_add_u32 v16, s20, v16
  v_add_u32 v17, s20, v17
  v_add_u32 v18, s20, v18
  v_add_u32 v19, s20, v19
  s_mov_b32 s80, 0
  s_branch L_q_side
L_q_own:
  s_add_u32 s21, s21, 131072
  v_add_u32 v22, s21, v22
  ds_write_b128 v22, v[72:75] offset:0
  ds_write_b128 v22, v[76:79] offset:1024
  ds_write_b128 v22, v[80:83] offset:2048
  ds_write_b128 v22, v[84:87] offset:3072
  ds_write_b128 v22, v[88:91] offset:4096
  ds_write_b128 v22, v[92:95] offset:5120
  s_waitcnt lgkmcnt(0)
  s_and_b32 s68, s3, 1
  s_lshr_b32 s67, s3, 1
  s_lshl_b32 s32, s35, 16
  s_and_b32 s24, s67, 1
  s_lshl_b32 s24, s24, 13
  v_lshrrev_b32 v5, 4, v0
  v_and_b32 v6, 15, v0
  v_lshrrev_b32 v7, 2, v6
  v_and_b32 v8, 3, v6
  v_lshl_add_u32 v8, v7, 3, v8
  v_and_b32 v9, 7, v6
  v_lshlrev_b32 v9, 1, v9
  v_xor_b32 v9, v9, v5
  v_lshlrev_b32 v9, 4, v9
  v_lshl_add_u32 v9, v8, 8, v9
  v_add_u32 v1, s24, v9
  v_and_b32 v8, 1, v5
  v_lshl_or_b32 v8, v8, 2, v7
  s_lshl_b32 s20, s67, 1
  v_xor_b32 v8, s20, v8
  v_lshlrev_b32 v8, 5, v8
  v_lshl_add_u32 v7, v5, 3, v7
  v_lshl_add_u32 v8, v7, 8, v8
  v_and_b32 v9, 3, v0
  v_lshl_add_u32 v8, v9, 3, v8
  v_add_u32 v2, s24, v8
  v_mov_b64 v[20:21], 0
  v_mov_b64 v[22:23], 0
  v_mov_b64 v[24:25], 0
  v_mov_b64 v[26:27], 0
  v_mov_b64 v[28:29], 0
  v_mov_b64 v[30:31], 0
  s_mov_b32 s69, 0xff800000
  s_mov_b32 s70, 0xff800000
  s_mov_b32 s87, 0
  v_add_u32 v248, s32, v1
  v_xor_b32 v249, 64, v248
  v_xor_b32 v250, 128, v248
  v_xor_b32 v251, 192, v248
  v_add_u32 v8, s32, v2
  v_xor_b32 v9, 32, v8
  v_xor_b32 v10, 64, v8
  v_xor_b32 v11, 96, v8
  v_xor_b32 v12, 128, v8
  v_xor_b32 v13, 160, v8
  v_xor_b32 v14, 192, v8
  v_xor_b32 v15, 224, v8
  s_add_u32 s33, s35, 4
  s_mov_b32 s28, 0
L_q_done:
  s_barrier
  s_and_b32 s20, s3, 1
  s_mul_i32 s20, s20, 12288
  s_add_u32 s20, s20, 131072
  v_lshlrev_b32 v7, 4, v0
  v_add_u32 v7, s20, v7
  ds_read_b128 v[104:107], v7 offset:0
  ds_read_b128 v[108:111], v7 offset:1024
  ds_read_b128 v[112:115], v7 offset:2048
  ds_read_b128 v[116:119], v7 offset:3072
  ds_read_b128 v[120:123], v7 offset:4096
  ds_read_b128 v[124:127], v7 offset:5120
  ds_read_b128 v[128:131], v7 offset:6144
  ds_read_b128 v[132:135], v7 offset:7168
  ds_read_b128 v[136:139], v7 offset:8192
  ds_read_b128 v[140:143], v7 offset:9216
  ds_read_b128 v[144:147], v7 offset:10240
  ds_read_b128 v[148:151], v7 offset:11264
  s_cmp_eq_u32 s35, 0
  s_cbranch_scc1 L_a_sa
  s_xor_b32 s20, 3, s29
  s_lshl_b32 s20, s20, 14
  s_add_u32 m0, s25, 98304
  s_add_u32 s20, s20, s25
  buffer_load_dwordx4 v3, s[4:7], s20 offen lds
  buffer_load_dwordx4 v3, s[4:7], s20 offen offset:1024 lds
  buffer_load_dwordx4 v4, s[4:7], s20 offen offset:2048 lds
  buffer_load_dwordx4 v4, s[4:7], s20 offen offset:3072 lds
  s_add_u32 m0, m0, 16384
  s_nop 0
  buffer_load_dwordx4 v3, s[8:11], s20 offen lds
  buffer_load_dwordx4 v3, s[8:11], s20 offen offset:1024 lds
  buffer_load_dwordx4 v4, s[8:11], s20 offen offset:2048 lds
  buffer_load_dwordx4 v4, s[8:11], s20 offen offset:3072 lds
  s_waitcnt vmcnt(16) lgkmcnt(0)
  s_barrier
  ds_read_b128 v[100:103], v251 offset:1024
  ds_read_b128 v[72:75], v248 offset:0
  ds_read_b128 v[76:79], v248 offset:1024
  ds_read_b128 v[80:83], v249 offset:0
  ds_read_b128 v[84:87], v249 offset:1024
  ds_read_b128 v[88:91], v250 offset:0
  ds_read_b128 v[92:95], v250 offset:1024
  ds_read_b128 v[96:99], v251 offset:0
  s_branch L_a_qk
L_a_sa:
  s_waitcnt lgkmcnt(6)
  ds_read_b128 v[100:103], v251 offset:1024
  ds_read_b128 v[72:75], v248 offset:0
  ds_read_b128 v[76:79], v248 offset:1024
  ds_read_b128 v[80:83], v249 offset:0
  ds_read_b128 v[84:87], v249 offset:1024
  ds_read_b128 v[88:91], v250 offset:0
  ds_read_b128 v[92:95], v250 offset:1024
  ds_read_b128 v[96:99], v251 offset:0
  v_mov_b32 v16, 0x3f803f80
  v_mov_b32 v17, 0x3f803f80
  v_mov_b32 v18, 0x3f803f80
  v_mov_b32 v19, 0x3f803f80
  v_mov_b64 v[32:33], 0
  v_mov_b64 v[34:35], 0
  v_mov_b64 v[36:37], 0
  v_mov_b64 v[38:39], 0
  v_mov_b64 v[40:41], 0
  v_mov_b64 v[42:43], 0
  v_mov_b64 v[152:153], 0
  v_mov_b64 v[154:155], 0
  v_mov_b64 v[156:157], 0
  v_mov_b64 v[158:159], 0
  v_mov_b64 v[160:161], 0
  v_mov_b64 v[162:163], 0
  v_mov_b64 v[164:165], 0
  v_mov_b64 v[166:167], 0
  v_mov_b64 v[168:169], 0
  v_mov_b64 v[170:171], 0
  v_mov_b64 v[172:173], 0
  v_mov_b64 v[174:175], 0
  v_mov_b64 v[176:177], 0
  v_mov_b64 v[178:179], 0
  v_mov_b64 v[180:181], 0
  v_mov_b64 v[182:183], 0
  s_branch L_a_qk
L_a_loop:
  ds_read_b128 v[100:103], v251 offset:1024
  v_mfma_f32_16x16x32_bf16 v[152:155], v[68:71], v[44:47], v[152:155]
  v_mfma_f32_16x16x32_bf16 v[156:159], v[68:71], v[52:55], v[156:159]
  v_mfma_f32_16x16x32_bf16 v[160:163], v[68:71], v[60:63], v[160:163]
  v_mfma_f32_16x16x32_bf16 v[164:167], v[72:75], v[44:47], v[164:167]
  v_mfma_f32_16x16x32_bf16 v[168:171], v[72:75], v[52:55], v[168:171]
  v_mfma_f32_16x16x32_bf16 v[172:175], v[72:75], v[60:63], v[172:175]
  ds_read_b128 v[72:75], v248 offset:0
  v_mfma_f32_16x16x32_bf16 v[176:179], v[76:79], v[44:47], v[176:179]
  v_mfma_f32_16x16x32_bf16 v[180:183], v[76:79], v[52:55], v[180:183]
  v_mfma_f32_16x16x32_bf16 v[184:187], v[76:79], v[60:63], v[184:187]
  ds_read_b128 v[76:79], v248 offset:1024
  v_mfma_f32_16x16x32_bf16 v[188:191], v[80:83], v[44:47], v[188:191]
  v_mfma_f32_16x16x32_bf16 v[192:195], v[80:83], v[52:55], v[192:195]
  v_mfma_f32_16x16x32_bf16 v[196:199], v[80:83], v[60:63], v[196:199]
  ds_read_b128 v[80:83], v249 offset:0
  v_mfma_f32_16x16x32_bf16 v[200:203], v[84:87], v[44:47], v[200:203]
  v_mfma_f32_16x16x32_bf16 v[204:207], v[84:87], v[52:55], v[204:207]
  v_mfma_f32_16x16x32_bf16 v[208:211], v[84:87], v[60:63], v[208:211]
  ds_read_b128 v[84:87], v249 offset:1024
  v_mfma_f32_16x16x32_bf16 v[212:215], v[88:91], v[44:47], v[212:215]
  v_mfma_f32_16x16x32_bf16 v[216:219], v[88:91], v[52:55], v[216:219]
  v_mfma_f32_16x16x32_bf16 v[220:223], v[88:91], v[60:63], v[220:223]
  ds_read_b128 v[88:91], v250 offset:0
  v_mfma_f32_16x16x32_bf16 v[224:227], v[92:95], v[44:47], v[224:227]
  v_mfma_f32_16x16x32_bf16 v[228:231], v[92:95], v[52:55], v[228:231]
  v_mfma_f32_16x16x32_bf16 v[232:235], v[92:95], v[60:63], v[232:235]
  ds_read_b128 v[92:95], v250 offset:1024
  v_mfma_f32_16x16x32_bf16 v[236:239], v[96:99], v[44:47], v[236:239]
  v_mfma_f32_16x16x32_bf16 v[240:243], v[96:99], v[52:55], v[240:243]
  v_mfma_f32_16x16x32_bf16 v[244:247], v[96:99], v[60:63], v[244:247]
  ds_read_b128 v[96:99], v251 offset:0
  v_mfma_f32_16x16x32_bf16 v[32:35], v[16:19], v[44:47], v[32:35]
  v_mfma_f32_16x16x32_bf16 v[36:39], v[16:19], v[52:55], v[36:39]
  v_mfma_f32_16x16x32_bf16 v[40:43], v[16:19], v[60:63], v[40:43]
L_a_qk:
  ds_read_b64_tr_b16 v[68:69], v8 offset:16384
  ds_read_b64_tr_b16 v[70:71], v8 offset:17408
  s_waitcnt lgkmcnt(8)
  v_mfma_f32_16x16x32_bf16 v[44:47], v[72:75], v[104:107], v[20:23]
  v_mfma_f32_16x16x32_bf16 v[52:55], v[72:75], v[108:111], v[24:27]
  v_mfma_f32_16x16x32_bf16 v[60:63], v[72:75], v[112:115], v[28:31]
  ds_read_b64_tr_b16 v[72:73], v9 offset:16384
  ds_read_b64_tr_b16 v[74:75], v9 offset:17408
  s_waitcnt lgkmcnt(9)
  v_mfma_f32_16x16x32_bf16 v[48:51], v[76:79], v[104:107], v[20:23]
  v_mfma_f32_16x16x32_bf16 v[56:59], v[76:79], v[108:111], v[24:27]
  v_mfma_f32_16x16x32_bf16 v[64:67], v[76:79], v[112:115], v[28:31]
  ds_read_b64_tr_b16 v[76:77], v10 offset:16384
  ds_read_b64_tr_b16 v[78:79], v10 offset:17408
  s_waitcnt lgkmcnt(10)
  v_mfma_f32_16x16x32_bf16 v[44:47], v[80:83], v[116:119], v[44:47]
  v_mfma_f32_16x16x32_bf16 v[52:55], v[80:83], v[120:123], v[52:55]
  v_mfma_f32_16x16x32_bf16 v[60:63], v[80:83], v[124:127], v[60:63]
  ds_read_b64_tr_b16 v[80:81], v11 offset:16384
  ds_read_b64_tr_b16 v[82:83], v11 offset:17408
  s_waitcnt lgkmcnt(11)
  v_mfma_f32_16x16x32_bf16 v[48:51], v[84:87], v[116:119], v[48:51]
  v_mfma_f32_16x16x32_bf16 v[56:59], v[84:87], v[120:123], v[56:59]
  v_mfma_f32_16x16x32_bf16 v[64:67], v[84:87], v[124:127], v[64:67]
  ds_read_b64_tr_b16 v[84:85], v12 offset:16384
  ds_read_b64_tr_b16 v[86:87], v12 offset:17408
  s_waitcnt lgkmcnt(12)
  v_mfma_f32_16x16x32_bf16 v[44:47], v[88:91], v[128:131], v[44:47]
  v_mfma_f32_16x16x32_bf16 v[52:55], v[88:91], v[132:135], v[52:55]
  v_mfma_f32_16x16x32_bf16 v[60:63], v[88:91], v[136:139], v[60:63]
  ds_read_b64_tr_b16 v[88:89], v13 offset:16384
  ds_read_b64_tr_b16 v[90:91], v13 offset:17408
  s_waitcnt lgkmcnt(13)
  v_mfma_f32_16x16x32_bf16 v[48:51], v[92:95], v[128:131], v[48:51]
  v_mfma_f32_16x16x32_bf16 v[56:59], v[92:95], v[132:135], v[56:59]
  v_mfma_f32_16x16x32_bf16 v[64:67], v[92:95], v[136:139], v[64:67]
  ds_read_b64_tr_b16 v[92:93], v14 offset:16384
  ds_read_b64_tr_b16 v[94:95], v14 offset:17408
  s_waitcnt lgkmcnt(14)
  v_mfma_f32_16x16x32_bf16 v[44:47], v[96:99], v[140:143], v[44:47]
  v_mfma_f32_16x16x32_bf16 v[52:55], v[96:99], v[144:147], v[52:55]
  v_mfma_f32_16x16x32_bf16 v[60:63], v[96:99], v[148:151], v[60:63]
  ds_read_b64_tr_b16 v[96:97], v15 offset:16384
  ds_read_b64_tr_b16 v[98:99], v15 offset:17408
  v_mfma_f32_16x16x32_bf16 v[48:51], v[100:103], v[140:143], v[48:51]
  v_mfma_f32_16x16x32_bf16 v[56:59], v[100:103], v[144:147], v[56:59]
  v_mfma_f32_16x16x32_bf16 v[64:67], v[100:103], v[148:151], v[64:67]
  s_add_u32 s23, s32, 0
  s_xor_b32 s20, s33, s29
  s_lshl_b32 s20, s20, 14
  s_add_u32 m0, s25, s23
  s_add_u32 s20, s20, s25
  s_add_u32 s33, s33, 2
  s_cmp_ge_u32 s28, 14
  s_waitcnt vmcnt(8) lgkmcnt(0)
  s_barrier
  s_cbranch_scc1 L_a_tail0
  buffer_load_dwordx4 v3, s[4:7], s20 offen lds
  v_max3_f32 v5, v44, v45, v46
  v_max3_f32 v6, v47, v52, v53
  v_max3_f32 v5, v54, v55, v5
  v_max3_f32 v6, v60, v61, v6
  v_max3_f32 v5, v62, v63, v5
  v_max3_f32 v6, v48, v49, v6
  buffer_load_dwordx4 v3, s[4:7], s20 offen offset:1024 lds
  v_max3_f32 v5, v50, v51, v5
  v_max3_f32 v6, v56, v57, v6
  v_max3_f32 v5, v58, v59, v5
  v_max3_f32 v6, v64, v65, v6
  v_max3_f32 v5, v66, v67, v5
  v_max_f32 v5, v5, v6
  v_cmp_nge_f32 vcc, s69, v5
  s_cbranch_vccz L_sm8
  s_call_b64 s[88:89], F_rare
L_sm8:
  buffer_load_dwordx4 v4, s[4:7], s20 offen offset:2048 lds
  v_exp_f32 v44, v44
  v_exp_f32 v45, v45
  v_exp_f32 v46, v46
  v_exp_f32 v47, v47
  buffer_load_dwordx4 v4, s[4:7], s20 offen offset:3072 lds
  s_add_u32 m0, m0, 16384
  v_exp_f32 v48, v48
  v_exp_f32 v49, v49
  v_exp_f32 v50, v50
  v_exp_f32 v51, v51
  v_cvt_pk_bf16_f32 v44, v44, v45
  v_cvt_pk_bf16_f32 v45, v46, v47
  v_cvt_pk_bf16_f32 v46, v48, v49
  v_cvt_pk_bf16_f32 v47, v50, v51
  buffer_load_dwordx4 v3, s[8:11], s20 offen lds
  v_exp_f32 v52, v52
  v_exp_f32 v53, v53
  v_exp_f32 v54, v54
  v_exp_f32 v55, v55
  buffer_load_dwordx4 v3, s[8:11], s20 offen offset:1024 lds
  v_exp_f32 v56, v56
  v_exp_f32 v57, v57
  v_exp_f32 v58, v58
  v_exp_f32 v59, v59
  v_cvt_pk_bf16_f32 v52, v52, v53
  v_cvt_pk_bf16_f32 v53, v54, v55
  v_cvt_pk_bf16_f32 v54, v56, v57
  v_cvt_pk_bf16_f32 v55, v58, v59
  buffer_load_dwordx4 v4, s[8:11], s20 offen offset:2048 lds
  v_exp_f32 v60, v60
  v_exp_f32 v61, v61
  v_exp_f32 v62, v62
  v_exp_f32 v63, v63
  buffer_load_dwordx4 v4, s[8:11], s20 offen offset:3072 lds
  v_exp_f32 v64, v64
  v_exp_f32 v65, v65
  v_exp_f32 v66, v66
  v_exp_f32 v67, v67
  v_cvt_pk_bf16_f32 v60, v60, v61
  v_cvt_pk_bf16_f32 v61, v62, v63
  v_cvt_pk_bf16_f32 v62, v64, v65
  v_cvt_pk_bf16_f32 v63, v66, v67
  s_add_u32 s28, s28, 1
  s_waitcnt vmcnt(8)
L_a_back:
  s_barrier
  ds_read_b128 v[100:103], v251 offset:33792
  v_mfma_f32_16x16x32_bf16 v[152:155], v[68:71], v[44:47], v[152:155]
  v_mfma_f32_16x16x32_bf16 v[156:159], v[68:71], v[52:55], v[156:159]
  v_mfma_f32_16x16x32_bf16 v[160:163], v[68:71], v[60:63], v[160:163]
  v_mfma_f32_16x16x32_bf16 v[164:167], v[72:75], v[44:47], v[164:167]
  v_mfma_f32_16x16x32_bf16 v[168:171], v[72:75], v[52:55], v[168:171]
  v_mfma_f32_16x16x32_bf16 v[172:175], v[72:75], v[60:63], v[172:175]
  ds_read_b128 v[72:75], v248 offset:32768
  v_mfma_f32_16x16x32_bf16 v[176:179], v[76:79], v[44:47], v[176:179]
  v_mfma_f32_16x16x32_bf16 v[180:183], v[76:79], v[52:55], v[180:183]
  v_mfma_f32_16x16x32_bf16 v[184:187], v[76:79], v[60:63], v[184:187]
  ds_read_b128 v[76:79], v248 offset:33792
  v_mfma_f32_16x16x32_bf16 v[188:191], v[80:83], v[44:47], v[188:191]
  v_mfma_f32_16x16x32_bf16 v[192:195], v[80:83], v[52:55], v[192:195]
  v_mfma_f32_16x16x32_bf16 v[196:199], v[80:83], v[60:63], v[196:199]
  ds_read_b128 v[80:83], v249 offset:32768
  v_mfma_f32_16x16x32_bf16 v[200:203], v[84:87], v[44:47], v[200:203]
  v_mfma_f32_16x16x32_bf16 v[204:207], v[84:87], v[52:55], v[204:207]
  v_mfma_f32_16x16x32_bf16 v[208:211], v[84:87], v[60:63], v[208:211]
  ds_read_b128 v[84:87], v249 offset:33792
  v_mfma_f32_16x16x32_bf16 v[212:215], v[88:91], v[44:47], v[212:215]
  v_mfma_f32_16x16x32_bf16 v[216:219], v[88:91], v[52:55], v[216:219]
  v_mfma_f32_16x16x32_bf16 v[220:223], v[88:91], v[60:63], v[220:223]
  ds_read_b128 v[88:91], v250 offset:32768
  v_mfma_f32_16x16x32_bf16 v[224:227], v[92:95], v[44:47], v[224:227]
  v_mfma_f32_16x16x32_bf16 v[228:231], v[92:95], v[52:55], v[228:231]
  v_mfma_f32_16x16x32_bf16 v[232:235], v[92:95], v[60:63], v[232:235]
  ds_read_b128 v[92:95], v250 offset:33792
  v_mfma_f32_16x16x32_bf16 v[236:239], v[96:99], v[44:47], v[236:239]
  v_mfma_f32_16x16x32_bf16 v[240:243], v[96:99], v[52:55], v[240:243]
  v_mfma_f32_16x16x32_bf16 v[244:247], v[96:99], v[60:63], v[244:247]
  ds_read_b128 v[96:99], v251 offset:32768
  v_mfma_f32_16x16x32_bf16 v[32:35], v[16:19], v[44:47], v[32:35]
  v_mfma_f32_16x16x32_bf16 v[36:39], v[16:19], v[52:55], v[36:39]
  v_mfma_f32_16x16x32_bf16 v[40:43], v[16:19], v[60:63], v[40:43]
  ds_read_b64_tr_b16 v[68:69], v8 offset:49152
  ds_read_b64_tr_b16 v[70:71], v8 offset:50176
  s_waitcnt lgkmcnt(8)
  v_mfma_f32_16x16x32_bf16 v[44:47], v[72:75], v[104:107], v[20:23]
  v_mfma_f32_16x16x32_bf16 v[52:55], v[72:75], v[108:111], v[24:27]
  v_mfma_f32_16x16x32_bf16 v[60:63], v[72:75], v[112:115], v[28:31]
  ds_read_b64_tr_b16 v[72:73], v9 offset:49152
  ds_read_b64_tr_b16 v[74:75], v9 offset:50176
  s_waitcnt lgkmcnt(9)
  v_mfma_f32_16x16x32_bf16 v[48:51], v[76:79], v[104:107], v[20:23]
  v_mfma_f32_16x16x32_bf16 v[56:59], v[76:79], v[108:111], v[24:27]
  v_mfma_f32_16x16x32_bf16 v[64:67], v[76:79], v[112:115], v[28:31]
  ds_read_b64_tr_b16 v[76:77], v10 offset:49152
  ds_read_b64_tr_b16 v[78:79], v10 offset:50176
  s_waitcnt lgkmcnt(10)
  v_mfma_f32_16x16x32_bf16 v[44:47], v[80:83], v[116:119], v[44:47]
  v_mfma_f32_16x16x32_bf16 v[52:55], v[80:83], v[120:123], v[52:55]
  v_mfma_f32_16x16x32_bf16 v[60:63], v[80:83], v[124:127], v[60:63]
  ds_read_b64_tr_b16 v[80:81], v11 offset:49152
  ds_read_b64_tr_b16 v[82:83], v11 offset:50176
  s_waitcnt lgkmcnt(11)
  v_mfma_f32_16x16x32_bf16 v[48:51], v[84:87], v[116:119], v[48:51]
  v_mfma_f32_16x16x32_bf16 v[56:59], v[84:87], v[120:123], v[56:59]
  v_mfma_f32_16x16x32_bf16 v[64:67], v[84:87], v[124:127], v[64:67]
  ds_read_b64_tr_b16 v[84:85], v12 offset:49152
  ds_read_b64_tr_b16 v[86:87], v12 offset:50176
  s_waitcnt lgkmcnt(12)
  v_mfma_f32_16x16x32_bf16 v[44:47], v[88:91], v[128:131], v[44:47]
  v_mfma_f32_16x16x32_bf16 v[52:55], v[88:91], v[132:135], v[52:55]
  v_mfma_f32_16x16x32_bf16 v[60:63], v[88:91], v[136:139], v[60:63]
  ds_read_b64_tr_b16 v[88:89], v13 offset:49152
  ds_read_b64_tr_b16 v[90:91], v13 offset:50176
  s_waitcnt lgkmcnt(13)
  v_mfma_f32_16x16x32_bf16 v[48:51], v[92:95], v[128:131], v[48:51]
  v_mfma_f32_16x16x32_bf16 v[56:59], v[92:95], v[132:135], v[56:59]
  v_mfma_f32_16x16x32_bf16 v[64:67], v[92:95], v[136:139], v[64:67]
  ds_read_b64_tr_b16 v[92:93], v14 offset:49152
  ds_read_b64_tr_b16 v[94:95], v14 offset:50176
  s_waitcnt lgkmcnt(14)
  v_mfma_f32_16x16x32_bf16 v[44:47], v[96:99], v[140:143], v[44:47]
  v_mfma_f32_16x16x32_bf16 v[52:55], v[96:99], v[144:147], v[52:55]
  v_mfma_f32_16x16x32_bf16 v[60:63], v[96:99], v[148:151], v[60:63]
  ds_read_b64_tr_b16 v[96:97], v15 offset:49152
  ds_read_b64_tr_b16 v[98:99], v15 offset:50176
  v_mfma_f32_16x16x32_bf16 v[48:51], v[100:103], v[140:143], v[48:51]
  v_mfma_f32_16x16x32_bf16 v[56:59], v[100:103], v[144:147], v[56:59]
  v_mfma_f32_16x16x32_bf16 v[64:67], v[100:103], v[148:151], v[64:67]
  s_add_u32 s23, s32, 32768
  s_xor_b32 s20, s33, s29
  s_lshl_b32 s20, s20, 14
  s_add_u32 m0, s25, s23
  s_add_u32 s20, s20, s25
  s_add_u32 s33, s33, 2
  s_cmp_ge_u32 s28, 14
  s_waitcnt vmcnt(8) lgkmcnt(0)
  s_barrier
  s_cbranch_scc1 L_a_tail1
  buffer_load_dwordx4 v3, s[4:7], s20 offen lds
  v_max3_f32 v5, v44, v45, v46
  v_max3_f32 v6, v47, v52, v53
  v_max3_f32 v5, v54, v55, v5
  v_max3_f32 v6, v60, v61, v6
  v_max3_f32 v5, v62, v63, v5
  v_max3_f32 v6, v48, v49, v6
  buffer_load_dwordx4 v3, s[4:7], s20 offen offset:1024 lds
  v_max3_f32 v5, v50, v51, v5
  v_max3_f32 v6, v56, v57, v6
  v_max3_f32 v5, v58, v59, v5
  v_max3_f32 v6, v64, v65, v6
  v_max3_f32 v5, v66, v67, v5
  v_max_f32 v5, v5, v6
  v_cmp_nge_f32 vcc, s69, v5
  s_cbranch_vccz L_sm9
  s_call_b64 s[88:89], F_rare
L_sm9:
  buffer_load_dwordx4 v4, s[4:7], s20 offen offset:2048 lds
  v_exp_f32 v44, v44
  v_exp_f32 v45, v45
  v_exp_f32 v46, v46
  v_exp_f32 v47, v47
  buffer_load_dwordx4 v4, s[4:7], s20 offen offset:3072 lds
  s_add_u32 m0, m0, 16384
  v_exp_f32 v48, v48
  v_exp_f32 v49, v49
  v_exp_f32 v50, v50
  v_exp_f32 v51, v51
  v_cvt_pk_bf16_f32 v44, v44, v45
  v_cvt_pk_bf16_f32 v45, v46, v47
  v_cvt_pk_bf16_f32 v46, v48, v49
  v_cvt_pk_bf16_f32 v47, v50, v51
  buffer_load_dwordx4 v3, s[8:11], s20 offen lds
  v_exp_f32 v52, v52
  v_exp_f32 v53, v53
  v_exp_f32 v54, v54
  v_exp_f32 v55, v55
  buffer_load_dwordx4 v3, s[8:11], s20 offen offset:1024 lds
  v_exp_f32 v56, v56
  v_exp_f32 v57, v57
  v_exp_f32 v58, v58
  v_exp_f32 v59, v59
  v_cvt_pk_bf16_f32 v52, v52, v53
  v_cvt_pk_bf16_f32 v53, v54, v55
  v_cvt_pk_bf16_f32 v54, v56, v57
  v_cvt_pk_bf16_f32 v55, v58, v59
  buffer_load_dwordx4 v4, s[8:11], s20 offen offset:2048 lds
  v_exp_f32 v60, v60
  v_exp_f32 v61, v61
  v_exp_f32 v62, v62
  v_exp_f32 v63, v63
  buffer_load_dwordx4 v4, s[8:11], s20 offen offset:3072 lds
  v_exp_f32 v64, v64
  v_exp_f32 v65, v65
  v_exp_f32 v66, v66
  v_exp_f32 v67, v67
  v_cvt_pk_bf16_f32 v60, v60, v61
  v_cvt_pk_bf16_f32 v61, v62, v63
  v_cvt_pk_bf16_f32 v62, v64, v65
  v_cvt_pk_bf16_f32 v63, v66, v67
  s_add_u32 s28, s28, 1
  s_waitcnt vmcnt(8)
  s_barrier
  s_branch L_a_loop
L_a_tail0:
  s_and_b32 s81, s81, 3
  s_xor_b32 s31, s81, s63
  s_and_b32 s31, s31, 3
  s_lshl_b32 s31, s31, 1
  s_xor_b32 s20, s82, 0
  s_lshl_b32 s20, s20, 7
  s_sub_u32 s21, 8388608, s20
  s_add_u32 s8, s44, s20
  s_addc_u32 s9, s45, 0
  s_mov_b32 s10, s21
  s_mov_b32 s11, 0x20000
  v_lshrrev_b32 v2, 3, v0
  v_and_b32 v3, 7, v0
  v_and_b32 v4, 6, v2
  v_xor_b32 v4, v3, v4
  v_lshlrev_b32 v4, 4, v4
  v_lshl_add_u32 v1, v2, 11, v4
  v_add_u32 v2, 15360, v1
  v_add_u32 v3, 30720, v1
  v_add_u32 v4, 46080, v1
  s_lshl_b32 s24, s83, 4
  s_add_u32 s24, s24, s3
  s_lshl_b32 s30, s24, 2
  s_and_b32 s20, s31, 3
  s_or_b32 s30, s30, s20
  s_and_b32 s20, s31, 4
  s_lshl_b32 s20, s20, 3
  s_or_b32 s30, s30, s20
  s_lshl_b32 s30, s30, 16
  s_lshl_b32 s78, s3, 13
  s_mul_i32 s20, s35, 98304
  s_add_u32 s78, s78, s20
  s_add_u32 m0, s78, 0
  s_xor_b32 s20, s30, 0
  buffer_load_dwordx4 v1, s[8:11], s20 offen lds
  v_max3_f32 v5, v44, v45, v46
  v_max3_f32 v6, v47, v52, v53
  v_max3_f32 v5, v54, v55, v5
  v_max3_f32 v6, v60, v61, v6
  v_max3_f32 v5, v62, v63, v5
  v_max3_f32 v6, v48, v49, v6
  buffer_load_dwordx4 v2, s[8:11], s20 offen offset:1024 lds
  v_max3_f32 v5, v50, v51, v5
  v_max3_f32 v6, v56, v57, v6
  v_max3_f32 v5, v58, v59, v5
  v_max3_f32 v6, v64, v65, v6
  v_max3_f32 v5, v66, v67, v5
  v_max_f32 v5, v5, v6
  v_cmp_nge_f32 vcc, s69, v5
  s_cbranch_vccz L_sm10
  s_call_b64 s[88:89], F_rare
L_sm10:
  buffer_load_dwordx4 v3, s[8:11], s20 offen offset:2048 lds
  v_exp_f32 v44, v44
  v_exp_f32 v45, v45
  v_exp_f32 v46, v46
  v_exp_f32 v47, v47
  buffer_load_dwordx4 v4, s[8:11], s20 offen offset:3072 lds
  v_exp_f32 v48, v48
  v_exp_f32 v49, v49
  v_exp_f32 v50, v50
  v_exp_f32 v51, v51
  v_cvt_pk_bf16_f32 v44, v44, v45
  v_cvt_pk_bf16_f32 v45, v46, v47
  v_cvt_pk_bf16_f32 v46, v48, v49
  v_cvt_pk_bf16_f32 v47, v50, v51
  s_add_u32 m0, s78, 4096
  s_xor_b32 s20, s30, 65536
  buffer_load_dwordx4 v1, s[8:11], s20 offen lds
  v_exp_f32 v52, v52
  v_exp_f32 v53, v53
  v_exp_f32 v54, v54
  v_exp_f32 v55, v55
  buffer_load_dwordx4 v2, s[8:11], s20 offen offset:1024 lds
  v_exp_f32 v56, v56
  v_exp_f32 v57, v57
  v_exp_f32 v58, v58
  v_exp_f32 v59, v59
  v_cvt_pk_bf16_f32 v52, v52, v53
  v_cvt_pk_bf16_f32 v53, v54, v55
  v_cvt_pk_bf16_f32 v54, v56, v57
  v_cvt_pk_bf16_f32 v55, v58, v59
  buffer_load_dwordx4 v3, s[8:11], s20 offen offset:2048 lds
  v_exp_f32 v60, v60
  v_exp_f32 v61, v61
  v_exp_f32 v62, v62
  v_exp_f32 v63, v63
  buffer_load_dwordx4 v4, s[8:11], s20 offen offset:3072 lds
  v_exp_f32 v64, v64
  v_exp_f32 v65, v65
  v_exp_f32 v66, v66
  v_exp_f32 v67, v67
  v_cvt_pk_bf16_f32 v60, v60, v61
  v_cvt_pk_bf16_f32 v61, v62, v63
  v_cvt_pk_bf16_f32 v62, v64, v65
  v_cvt_pk_bf16_f32 v63, v66, v67
  s_add_u32 s28, s28, 1
  s_waitcnt vmcnt(8)
  s_branch L_a_back
L_a_tail1:
  v_max3_f32 v5, v44, v45, v46
  v_max3_f32 v6, v47, v52, v53
  v_max3_f32 v5, v54, v55, v5
  v_max3_f32 v6, v60, v61, v6
  v_max3_f32 v5, v62, v63, v5
  v_max3_f32 v6, v48, v49, v6
  v_max3_f32 v5, v50, v51, v5
  v_max3_f32 v6, v56, v57, v6
  v_max3_f32 v5, v58, v59, v5
  v_max3_f32 v6, v64, v65, v6
  v_max3_f32 v5, v66, v67, v5
  v_max_f32 v5, v5, v6
  v_cmp_nge_f32 vcc, s69, v5
  s_cbranch_vccz L_sm11
  s_call_b64 s[88:89], F_rare
L_sm11:
  v_exp_f32 v44, v44
  v_exp_f32 v45, v45
  v_exp_f32 v46, v46
  v_exp_f32 v47, v47
  v_exp_f32 v48, v48
  v_exp_f32 v49, v49
  v_exp_f32 v50, v50
  v_exp_f32 v51, v51
  v_cvt_pk_bf16_f32 v44, v44, v45
  v_cvt_pk_bf16_f32 v45, v46, v47
  v_cvt_pk_bf16_f32 v46, v48, v49
  v_cvt_pk_bf16_f32 v47, v50, v51
  v_exp_f32 v52, v52
  v_exp_f32 v53, v53
  v_exp_f32 v54, v54
  v_exp_f32 v55, v55
  v_exp_f32 v56, v56
  v_exp_f32 v57, v57
  v_exp_f32 v58, v58
  v_exp_f32 v59, v59
  v_cvt_pk_bf16_f32 v52, v52, v53
  v_cvt_pk_bf16_f32 v53, v54, v55
  v_cvt_pk_bf16_f32 v54, v56, v57
  v_cvt_pk_bf16_f32 v55, v58, v59
  v_exp_f32 v60, v60
  v_exp_f32 v61, v61
  v_exp_f32 v62, v62
  v_exp_f32 v63, v63
  v_exp_f32 v64, v64
  v_exp_f32 v65, v65
  v_exp_f32 v66, v66
  v_exp_f32 v67, v67
  v_cvt_pk_bf16_f32 v60, v60, v61
  v_cvt_pk_bf16_f32 v61, v62, v63
  v_cvt_pk_bf16_f32 v62, v64, v65
  v_cvt_pk_bf16_f32 v63, v66, v67
  v_mfma_f32_16x16x32_bf16 v[32:35], v[16:19], v[44:47], v[32:35]
  v_mfma_f32_16x16x32_bf16 v[36:39], v[16:19], v[52:55], v[36:39]
  v_mfma_f32_16x16x32_bf16 v[40:43], v[16:19], v[60:63], v[40:43]
  s_mul_i32 s20, s68, 36864
  s_xor_b32 s21, s67, 1
  s_mul_i32 s21, s21, 9216
  s_add_u32 s21, s21, 32768
  s_add_u32 s4, s21, s20
  s_xor_b32 s21, s67, 2
  s_mul_i32 s21, s21, 9216
  s_add_u32 s21, s21, 35840
  s_add_u32 s5, s21, s20
  s_xor_b32 s21, s67, 3
  s_mul_i32 s21, s21, 9216
  s_add_u32 s21, s21, 38912
  s_add_u32 s6, s21, s20
  s_mul_i32 s21, s67, 9216
  s_add_u32 s21, s21, 32768
  s_add_u32 s7, s21, s20
  s_add_u32 s27, s66, s68
  s_lshl_b32 s27, s27, 2
  s_add_u32 s27, s27, s67
  s_mul_i32 s27, s27, 3072
  s_mul_i32 s20, s68, 192
  s_add_u32 s20, s20, s67
  s_lshl_b32 s20, s20, 3
  s_add_u32 s20, s20, 106496
  s_lshl_b32 s21, s68, 4
  s_add_u32 s21, s21, 106496
  s_lshl_b32 s26, s67, 2
  s_add_u32 s26, s26, s21
  s_cmp_eq_u32 s35, 0
  s_cbranch_scc0 L_ig12
  s_barrier
L_ig12:
  s_call_b64 s[88:89], F_last
  s_mov_b32 s28, 0
  s_lshl_b32 s27, 0, 3
  s_add_u32 s27, s27, s81
  s_lshl_b32 s27, s27, 5
  s_add_u32 s27, s27, s24
  s_lshl_b32 s36, s31, 1
  s_and_b32 s36, s36, 8
  s_or_b32 s36, s36, s27
  s_lshl_b32 s36, s36, 7
  s_add_u32 s36, s36, 12582912
  s_xor_b32 s37, s36, 1024
  s_waitcnt vmcnt(0)
  s_barrier
  s_cmp_eq_u32 s3, 0
  s_cbranch_scc0 L_o_nsig
  s_lshl_b32 s20, s66, 7
  s_add_u32 s20, s20, 12582912
  v_lshlrev_b32 v12, 7, v0
  v_mov_b32 v13, 1
  s_mov_b64 exec, 3
  buffer_store_dword v13, v12, s[12:15], s20 offen sc1
  s_mov_b64 exec, -1
L_o_nsig:
  s_mov_b32 s16, s56
  s_mov_b32 s17, s57
  s_mov_b32 s18, 1572864
  s_mov_b32 s19, 0x20000
  v_lshlrev_b32 v5, 4, v0
  v_lshrrev_b32 v12, 2, v0
  v_bfe_u32 v13, v0, 3, 2
  s_lshl_b32 s20, s83, 1
  v_xor_b32 v13, s20, v13
  v_lshlrev_b32 v13, 5, v13
  v_lshl_add_u32 v13, v12, 7, v13
  v_and_b32 v14, 3, v0
  v_lshl_add_u32 v13, v14, 3, v13
  v_add_u32 v6, s78, v13
  v_xor_b32 v7, 32, v6
  v_xor_b32 v8, 64, v6
  v_xor_b32 v9, 96, v6
  s_and_b32 s20, s31, 3
  s_xor_b32 s72, s20, 0
  s_mul_i32 s72, s72, 3072
  s_xor_b32 s73, s20, 1
  s_mul_i32 s73, s73, 3072
  s_xor_b32 s74, s20, 2
  s_mul_i32 s74, s74, 3072
  s_xor_b32 s75, s20, 3
  s_mul_i32 s75, s75, 3072
  s_lshr_b32 s20, s31, 2
  s_mul_i32 s76, s20, 98304
  s_sub_u32 s77, 98304, s76
  s_mul_i32 s79, s3, 12288
  s_add_u32 s79, s79, 32768
  s_cmp_ge_u32 s3, 3
  s_cselect_b32 s20, 3, 0
  s_sub_u32 s67, s3, s20
  s_min_u32 s67, s67, 3
  s_and_b32 s20, s81, 3
  s_lshl_b32 s20, s20, 4
  s_add_u32 s20, s20, s82
  s_lshl_b32 s20, s20, 1
  s_add_u32 s20, s20, s83
  s_lshl_b32 s20, s20, 1
  s_cmp_ge_u32 s3, 3
  s_addc_u32 s20, s20, 0
  s_xor_b32 s20, s20, 3
  s_mul_i32 s21, s20, 3
  s_add_u32 s21, s21, s67
  s_lshl_b32 s21, s21, 11
  s_add_u32 s21, s21, 6291456
  s_lshl_b32 s20, s20, 2
  s_add_u32 s20, s20, s67
  s_lshl_b32 s20, s20, 7
  s_add_u32 s20, s20, 12648448
  s_mov_b32 s4, s21
  s_mov_b32 s5, s20
  s_and_b32 s20, s81, 3
  s_lshl_b32 s20, s20, 4
  s_add_u32 s20, s20, s82
  s_lshl_b32 s20, s20, 1
  s_add_u32 s20, s20, s83
  s_lshl_b32 s20, s20, 1
  s_cmp_ge_u32 s3, 3
  s_addc_u32 s20, s20, 0
  s_mul_i32 s21, s20, 3
  s_add_u32 s21, s21, s67
  s_lshl_b32 s21, s21, 11
  s_add_u32 s21, s21, 6291456
  s_lshl_b32 s20, s20, 2
  s_add_u32 s20, s20, s67
  s_lshl_b32 s20, s20, 7
  s_add_u32 s20, s20, 12648448
  s_mov_b32 s6, s21
  s_mov_b32 s38, s20
  s_cmp_ge_u32 s3, 3
  s_cselect_b32 s20, 4, 0
  s_add_u32 s20, s20, s81
  s_mul_i32 s20, s20, 3
  s_add_u32 s20, s20, s67
  s_lshl_b32 s20, s20, 10
  s_add_u32 s20, s20, s83
  s_lshl_b32 s20, s20, 6
  s_lshl_b32 s69, s82, 7
  s_xor_b32 s70, s69, 2560
  s_add_u32 s69, s69, s20
  s_add_u32 s70, s70, s20
  s_mov_b32 s66, 0
  v_mov_b64 v[16:17], 0
  v_mov_b64 v[18:19], 0
  v_mov_b64 v[20:21], 0
  v_mov_b64 v[22:23], 0
  v_mov_b64 v[24:25], 0
  v_mov_b64 v[26:27], 0
  v_mov_b64 v[28:29], 0
  v_mov_b64 v[30:31], 0
  v_mov_b64 v[32:33], 0
  v_mov_b64 v[34:35], 0
  v_mov_b64 v[36:37], 0
  v_mov_b64 v[38:39], 0
  v_mov_b64 v[40:41], 0
  v_mov_b64 v[42:43], 0
  v_mov_b64 v[44:45], 0
  v_mov_b64 v[46:47], 0
  v_mov_b64 v[48:49], 0
  v_mov_b64 v[50:51], 0
  v_mov_b64 v[52:53], 0
  v_mov_b64 v[54:55], 0
  v_mov_b64 v[56:57], 0
  v_mov_b64 v[58:59], 0
  v_mov_b64 v[60:61], 0
  v_mov_b64 v[62:63], 0
  s_mov_b32 s80, 0
L_o_side:
  s_setprio 3
  s_waitcnt vmcnt(4)
  ds_read_b64_tr_b16 v[128:129], v6 offset:0
  ds_read_b64_tr_b16 v[130:131], v6 offset:2048
  ds_read_b64_tr_b16 v[132:133], v7 offset:0
  ds_read_b64_tr_b16 v[134:135], v7 offset:2048
  ds_read_b64_tr_b16 v[136:137], v8 offset:0
  ds_read_b64_tr_b16 v[138:139], v8 offset:2048
  ds_read_b64_tr_b16 v[140:141], v9 offset:0
  ds_read_b64_tr_b16 v[142:143], v9 offset:2048
  s_waitcnt lgkmcnt(0)
  s_add_u32 m0, s78, 0
  s_xor_b32 s20, s30, 131072
  buffer_load_dwordx4 v1, s[8:11], s20 offen lds
  buffer_load_dwordx4 v2, s[8:11], s20 offen offset:1024 lds
  buffer_load_dwordx4 v3, s[8:11], s20 offen offset:2048 lds
  buffer_load_dwordx4 v4, s[8:11], s20 offen offset:3072 lds
  s_waitcnt vmcnt(4)
  ds_read_b64_tr_b16 v[144:145], v6 offset:4096
  ds_read_b64_tr_b16 v[146:147], v6 offset:6144
  ds_read_b64_tr_b16 v[148:149], v7 offset:4096
  ds_read_b64_tr_b16 v[150:151], v7 offset:6144
  ds_read_b64_tr_b16 v[152:153], v8 offset:4096
  ds_read_b64_tr_b16 v[154:155], v8 offset:6144
  ds_read_b64_tr_b16 v[156:157], v9 offset:4096
  ds_read_b64_tr_b16 v[158:159], v9 offset:6144
  s_waitcnt lgkmcnt(0)
  s_add_u32 m0, s78, 4096
  s_xor_b32 s20, s30, 196608
  buffer_load_dwordx4 v1, s[8:11], s20 offen lds
  buffer_load_dwordx4 v2, s[8:11], s20 offen offset:1024 lds
  buffer_load_dwordx4 v3, s[8:11], s20 offen offset:2048 lds
  buffer_load_dwordx4 v4, s[8:11], s20 offen offset:3072 lds
  s_waitcnt vmcnt(4)
  ds_read_b64_tr_b16 v[160:161], v6 offset:0
  ds_read_b64_tr_b16 v[162:163], v6 offset:2048
  ds_read_b64_tr_b16 v[164:165], v7 offset:0
  ds_read_b64_tr_b16 v[166:167], v7 offset:2048
  ds_read_b64_tr_b16 v[168:169], v8 offset:0
  ds_read_b64_tr_b16 v[170:171], v8 offset:2048
  ds_read_b64_tr_b16 v[172:173], v9 offset:0
  ds_read_b64_tr_b16 v[174:175], v9 offset:2048
  s_waitcnt lgkmcnt(0)
  s_add_u32 m0, s78, 0
  s_xor_b32 s20, s30, 2097152
  buffer_load_dwordx4 v1, s[8:11], s20 offen lds
  buffer_load_dwordx4 v2, s[8:11], s20 offen offset:1024 lds
  buffer_load_dwordx4 v3, s[8:11], s20 offen offset:2048 lds
  buffer_load_dwordx4 v4, s[8:11], s20 offen offset:3072 lds
  s_waitcnt vmcnt(4)
  ds_read_b64_tr_b16 v[176:177], v6 offset:4096
  ds_read_b64_tr_b16 v[178:179], v6 offset:6144
  ds_read_b64_tr_b16 v[180:181], v7 offset:4096
  ds_read_b64_tr_b16 v[182:183], v7 offset:6144
  ds_read_b64_tr_b16 v[184:185], v8 offset:4096
  ds_read_b64_tr_b16 v[186:187], v8 offset:6144
  ds_read_b64_tr_b16 v[188:189], v9 offset:4096
  ds_read_b64_tr_b16 v[190:191], v9 offset:6144
  s_waitcnt lgkmcnt(0)
  s_add_u32 m0, s78, 4096
  s_xor_b32 s20, s30, 2162688
  buffer_load_dwordx4 v1, s[8:11], s20 offen lds
  buffer_load_dwordx4 v2, s[8:11], s20 offen offset:1024 lds
  buffer_load_dwordx4 v3, s[8:11], s20 offen offset:2048 lds
  buffer_load_dwordx4 v4, s[8:11], s20 offen offset:3072 lds
  s_setprio 2
  s_waitcnt vmcnt(4)
  ds_read_b64_tr_b16 v[192:193], v6 offset:0
  ds_read_b64_tr_b16 v[194:195], v6 offset:2048
  ds_read_b64_tr_b16 v[196:197], v7 offset:0
  ds_read_b64_tr_b16 v[198:199], v7 offset:2048
  ds_read_b64_tr_b16 v[200:201], v8 offset:0
  ds_read_b64_tr_b16 v[202:203], v8 offset:2048
  ds_read_b64_tr_b16 v[204:205], v9 offset:0
  ds_read_b64_tr_b16 v[206:207], v9 offset:2048
  s_waitcnt lgkmcnt(0)
  s_add_u32 m0, s78, 0
  s_xor_b32 s20, s30, 2228224
  buffer_load_dwordx4 v1, s[8:11], s20 offen lds
  buffer_load_dwordx4 v2, s[8:11], s20 offen offset:1024 lds
  buffer_load_dwordx4 v3, s[8:11], s20 offen offset:2048 lds
  buffer_load_dwordx4 v4, s[8:11], s20 offen offset:3072 lds
  s_load_dword s39, s[60:61], s36 glc
  s_load_dword s40, s[60:61], s37 glc
  s_load_dword s41, s[60:61], s38 glc
  s_waitcnt vmcnt(4)
  ds_read_b64_tr_b16 v[208:209], v6 offset:4096
  ds_read_b64_tr_b16 v[210:211], v6 offset:6144
  ds_read_b64_tr_b16 v[212:213], v7 offset:4096
  ds_read_b64_tr_b16 v[214:215], v7 offset:6144
  ds_read_b64_tr_b16 v[216:217], v8 offset:4096
  ds_read_b64_tr_b16 v[218:219], v8 offset:6144
  ds_read_b64_tr_b16 v[220:221], v9 offset:4096
  ds_read_b64_tr_b16 v[222:223], v9 offset:6144
  s_waitcnt lgkmcnt(0)
  s_add_u32 m0, s78, 4096
  s_xor_b32 s20, s30, 2293760
  buffer_load_dwordx4 v1, s[8:11], s20 offen lds
  buffer_load_dwordx4 v2, s[8:11], s20 offen offset:1024 lds
  buffer_load_dwordx4 v3, s[8:11], s20 offen offset:2048 lds
  buffer_load_dwordx4 v4, s[8:11], s20 offen offset:3072 lds
  s_waitcnt lgkmcnt(0)
  s_lshl1_add_u32 s42, s40, s39
  s_lshl2_add_u32 s42, s41, s42
  s_mov_b32 s71, 0
L_fc13:
  s_andn2_b32 s20, 3, s42
  s_cbranch_scc0 L_fo14
  s_sleep 8
  s_call_b64 s[88:89], F_poll
  s_branch L_fc13
L_fo14:
  s_mul_i32 s32, s27, 12288
  s_add_u32 s33, s32, s76
  s_mov_b64 vcc, 1
  s_call_b64 s[88:89], F_prime
  s_add_u32 s36, s36, 16384
  s_add_u32 s37, s37, 16384
  s_waitcnt vmcnt(16)
  ds_read_b64_tr_b16 v[224:225], v6 offset:0
  ds_read_b64_tr_b16 v[226:227], v6 offset:2048
  ds_read_b64_tr_b16 v[228:229], v7 offset:0
  ds_read_b64_tr_b16 v[230:231], v7 offset:2048
  ds_read_b64_tr_b16 v[232:233], v8 offset:0
  ds_read_b64_tr_b16 v[234:235], v8 offset:2048
  ds_read_b64_tr_b16 v[236:237], v9 offset:0
  ds_read_b64_tr_b16 v[238:239], v9 offset:2048
  s_setprio 1
  s_waitcnt vmcnt(12)
  ds_read_b64_tr_b16 v[240:241], v6 offset:4096
  ds_read_b64_tr_b16 v[242:243], v6 offset:6144
  ds_read_b64_tr_b16 v[244:245], v7 offset:4096
  ds_read_b64_tr_b16 v[246:247], v7 offset:6144
  ds_read_b64_tr_b16 v[248:249], v8 offset:4096
  ds_read_b64_tr_b16 v[250:251], v8 offset:6144
  ds_read_b64_tr_b16 v[252:253], v9 offset:4096
  ds_read_b64_tr_b16 v[254:255], v9 offset:6144
  s_waitcnt lgkmcnt(0)
  s_load_dword s39, s[60:61], s36 glc
  s_load_dword s40, s[60:61], s37 glc
  s_load_dword s41, s[60:61], s38 glc
  s_setprio 1
  s_add_u32 s33, s32, s77
  s_mov_b64 vcc, 1
  s_call_b64 s[88:89], F_h0
  s_setprio 0
  s_add_u32 s32, s32, 1572864
  s_waitcnt lgkmcnt(0)
  s_lshl1_add_u32 s42, s40, s39
  s_lshl2_add_u32 s42, s41, s42
  s_cmp_eq_u32 s80, 0
  s_cbranch_scc0 L_o_sb
  s_mov_b32 s71, 0
L_fc15:
  s_andn2_b32 s20, 3, s42
  s_cbranch_scc0 L_fo16
  s_sleep 8
  s_call_b64 s[88:89], F_poll
  s_branch L_fc15
L_fo16:
  s_add_u32 s33, s32, s76
  s_mov_b64 vcc, 1
  s_call_b64 s[88:89], F_h1
  s_call_b64 s[88:89], F_red
  s_setprio 1
  s_add_u32 s33, s32, s77
  s_mov_b64 vcc, 1
  s_call_b64 s[88:89], F_h0
  s_setprio 0
  s_mov_b64 vcc, 0
  s_call_b64 s[88:89], F_h1
  s_xor_b32 s20, s82, 4
  s_lshl_b32 s20, s20, 7
  s_sub_u32 s21, 8388608, s20
  s_add_u32 s8, s54, s20
  s_addc_u32 s9, s55, 0
  s_mov_b32 s10, s21
  s_mov_b32 s11, 0x20000
  s_lshl_b32 s27, 1, 3
  s_add_u32 s27, s27, s81
  s_lshl_b32 s27, s27, 5
  s_add_u32 s27, s27, s24
  s_lshl_b32 s36, s31, 1
  s_and_b32 s36, s36, 8
  s_or_b32 s36, s36, s27
  s_lshl_b32 s36, s36, 7
  s_add_u32 s36, s36, 12582912
  s_xor_b32 s37, s36, 1024
  s_add_u32 m0, s78, 0
  s_xor_b32 s20, s30, 0
  buffer_load_dwordx4 v1, s[8:11], s20 offen lds
  buffer_load_dwordx4 v2, s[8:11], s20 offen offset:1024 lds
  buffer_load_dwordx4 v3, s[8:11], s20 offen offset:2048 lds
  buffer_load_dwordx4 v4, s[8:11], s20 offen offset:3072 lds
  s_add_u32 m0, s78, 4096
  s_xor_b32 s20, s30, 65536
  buffer_load_dwordx4 v1, s[8:11], s20 offen lds
  buffer_load_dwordx4 v2, s[8:11], s20 offen offset:1024 lds
  buffer_load_dwordx4 v3, s[8:11], s20 offen offset:2048 lds
  buffer_load_dwordx4 v4, s[8:11], s20 offen offset:3072 lds
  s_call_b64 s[88:89], F_red
  s_mov_b32 s80, 1
  s_branch L_o_side
L_o_sb:
  s_and_b32 s25, s42, 2
  s_bitcmp1_b32 s42, 0
  s_cselect_b32 s25, 1, s25
  s_cselect_b32 s20, s76, s77
  s_add_u32 s33, s32, s20
  s_cmp_lg_u32 s25, 0
  s_cselect_b64 vcc, 1, 0
  s_load_dword s39, s[60:61], s36 glc
  s_load_dword s40, s[60:61], s37 glc
  s_load_dword s41, s[60:61], s38 glc
  s_call_b64 s[88:89], F_h1
  s_waitcnt lgkmcnt(0)
  s_lshl1_add_u32 s42, s40, s39
  s_lshl2_add_u32 s42, s41, s42
  s_cmp_lg_u32 s25, 0
  s_cbranch_scc1 L_o_np
  s_and_b32 s25, s42, 2
  s_bitcmp1_b32 s42, 0
  s_cselect_b32 s25, 1, s25
  s_cselect_b32 s20, s76, s77
  s_add_u32 s33, s32, s20
  s_cmp_eq_u32 s25, 0
  s_cbranch_scc1 L_o_np
  s_call_b64 s[88:89], F_prime
L_o_np:
  s_mov_b32 s23, 3
  v_and_b32 v1, 15, v0
  v_lshlrev_b32 v1, 12, v1
  v_lshrrev_b32 v2, 5, v0
  v_lshl_add_u32 v1, v2, 4, v1
  v_bfe_u32 v2, v0, 4, 1
  v_lshl_add_u32 v1, v2, 5, v1
  s_call_b64 s[88:89], F_red
  s_waitcnt lgkmcnt(0)
  s_lshl1_add_u32 s42, s40, s39
  s_lshl2_add_u32 s42, s41, s42
  s_mov_b32 s71, 0
  s_cmp_lg_u32 s25, 0
  s_cbranch_scc1 L_o_run
  s_and_b32 s22, s42, 3
  s_cbranch_scc1 L_o_tgo
L_o_tw:
  s_waitcnt vmcnt(0)
  s_cmp_eq_u32 s34, 0
  s_cbranch_scc1 L_sf17
  v_mov_b32 v12, 0
  v_mov_b32 v13, 1
  s_mov_b64 exec, 1
  buffer_store_dword v13, v12, s[12:15], s34 offen sc1
  s_mov_b64 exec, -1
  s_mov_b32 s34, 0
L_sf17:
L_o_tp:
  s_call_b64 s[88:89], F_poll
  s_and_b32 s22, s42, s23
  s_cbranch_scc1 L_o_tgo
  s_sleep 10
  s_branch L_o_tp
L_o_tgo:
  s_and_b32 s25, s22, 2
  s_bitcmp1_b32 s22, 0
  s_cselect_b32 s25, 1, s25
  s_cselect_b32 s20, s76, s77
  s_add_u32 s33, s32, s20
  s_call_b64 s[88:89], F_prime
L_o_run:
  s_xor_b32 s23, s23, s25
  s_and_b32 s22, s42, s23
  s_cselect_b64 vcc, 1, 0
  s_load_dword s39, s[60:61], s36 glc
  s_load_dword s40, s[60:61], s37 glc
  s_load_dword s41, s[60:61], s38 glc
  s_cmp_eq_u32 s25, 1
  s_cbranch_scc0 L_o_r1
  s_add_u32 s33, s32, s77
  s_call_b64 s[88:89], F_h0
  s_waitcnt lgkmcnt(0)
  s_lshl1_add_u32 s42, s40, s39
  s_lshl2_add_u32 s42, s41, s42
  s_cmp_eq_u32 s23, 0
  s_cbranch_scc1 L_o_a0
  s_cbranch_vccnz L_o_k0
  s_and_b32 s22, s42, s23
  s_cbranch_scc0 L_o_k0
  s_call_b64 s[88:89], F_prime
L_o_k0:
  v_mov_b64 v[128:129], v[16:17]
  v_mov_b64 v[130:131], v[18:19]
  v_mov_b64 v[132:133], v[20:21]
  v_mov_b64 v[134:135], v[22:23]
  v_mov_b64 v[136:137], v[24:25]
  v_mov_b64 v[138:139], v[26:27]
  v_mov_b64 v[140:141], v[28:29]
  v_mov_b64 v[142:143], v[30:31]
  v_mov_b64 v[144:145], v[32:33]
  v_mov_b64 v[146:147], v[34:35]
  v_mov_b64 v[148:149], v[36:37]
  v_mov_b64 v[150:151], v[38:39]
  v_mov_b64 v[152:153], v[40:41]
  v_mov_b64 v[154:155], v[42:43]
  v_mov_b64 v[156:157], v[44:45]
  v_mov_b64 v[158:159], v[46:47]
  v_mov_b64 v[160:161], v[48:49]
  v_mov_b64 v[162:163], v[50:51]
  v_mov_b64 v[164:165], v[52:53]
  v_mov_b64 v[166:167], v[54:55]
  v_mov_b64 v[168:169], v[56:57]
  v_mov_b64 v[170:171], v[58:59]
  v_mov_b64 v[172:173], v[60:61]
  v_mov_b64 v[174:175], v[62:63]
  s_branch L_o_pk
L_o_r1:
  s_add_u32 s33, s32, s76
  s_call_b64 s[88:89], F_h1
  s_waitcnt lgkmcnt(0)
  s_lshl1_add_u32 s42, s40, s39
  s_lshl2_add_u32 s42, s41, s42
  s_cmp_eq_u32 s23, 0
  s_cbranch_scc1 L_o_a1
  s_cbranch_vccnz L_o_k1
  s_and_b32 s22, s42, s23
  s_cbranch_scc0 L_o_k1
  s_call_b64 s[88:89], F_prime
L_o_k1:
  v_mov_b64 v[192:193], v[16:17]
  v_mov_b64 v[194:195], v[18:19]
  v_mov_b64 v[196:197], v[20:21]
  v_mov_b64 v[198:199], v[22:23]
  v_mov_b64 v[200:201], v[24:25]
  v_mov_b64 v[202:203], v[26:27]
  v_mov_b64 v[204:205], v[28:29]
  v_mov_b64 v[206:207], v[30:31]
  v_mov_b64 v[208:209], v[32:33]
  v_mov_b64 v[210:211], v[34:35]
  v_mov_b64 v[212:213], v[36:37]
  v_mov_b64 v[214:215], v[38:39]
  v_mov_b64 v[216:217], v[40:41]
  v_mov_b64 v[218:219], v[42:43]
  v_mov_b64 v[220:221], v[44:45]
  v_mov_b64 v[222:223], v[46:47]
  v_mov_b64 v[224:225], v[48:49]
  v_mov_b64 v[226:227], v[50:51]
  v_mov_b64 v[228:229], v[52:53]
  v_mov_b64 v[230:231], v[54:55]
  v_mov_b64 v[232:233], v[56:57]
  v_mov_b64 v[234:235], v[58:59]
  v_mov_b64 v[236:237], v[60:61]
  v_mov_b64 v[238:239], v[62:63]
L_o_pk:
  v_mov_b64 v[16:17], 0
  v_mov_b64 v[18:19], 0
  v_mov_b64 v[20:21], 0
  v_mov_b64 v[22:23], 0
  v_mov_b64 v[24:25], 0
  v_mov_b64 v[26:27], 0
  v_mov_b64 v[28:29], 0
  v_mov_b64 v[30:31], 0
  v_mov_b64 v[32:33], 0
  v_mov_b64 v[34:35], 0
  v_mov_b64 v[36:37], 0
  v_mov_b64 v[38:39], 0
  v_mov_b64 v[40:41], 0
  v_mov_b64 v[42:43], 0
  v_mov_b64 v[44:45], 0
  v_mov_b64 v[46:47], 0
  v_mov_b64 v[48:49], 0
  v_mov_b64 v[50:51], 0
  v_mov_b64 v[52:53], 0
  v_mov_b64 v[54:55], 0
  v_mov_b64 v[56:57], 0
  v_mov_b64 v[58:59], 0
  v_mov_b64 v[60:61], 0
  v_mov_b64 v[62:63], 0
  s_cmp_eq_u32 s22, 0
  s_cbranch_scc1 L_o_tw
  s_waitcnt vmcnt(12)
  s_cmp_eq_u32 s34, 0
  s_cbranch_scc1 L_sf18
  v_mov_b32 v12, 0
  v_mov_b32 v13, 1
  s_mov_b64 exec, 1
  buffer_store_dword v13, v12, s[12:15], s34 offen sc1
  s_mov_b64 exec, -1
  s_mov_b32 s34, 0
L_sf18:
  s_mov_b32 s25, s22
  s_branch L_o_run
L_o_a0:
  v_pk_add_f32 v[16:17], v[16:17], v[192:193]
  v_pk_add_f32 v[18:19], v[18:19], v[194:195]
  v_pk_add_f32 v[20:21], v[20:21], v[196:197]
  v_pk_add_f32 v[22:23], v[22:23], v[198:199]
  v_pk_add_f32 v[24:25], v[24:25], v[200:201]
  v_pk_add_f32 v[26:27], v[26:27], v[202:203]
  v_pk_add_f32 v[28:29], v[28:29], v[204:205]
  v_pk_add_f32 v[30:31], v[30:31], v[206:207]
  v_pk_add_f32 v[32:33], v[32:33], v[208:209]
  v_pk_add_f32 v[34:35], v[34:35], v[210:211]
  v_pk_add_f32 v[36:37], v[36:37], v[212:213]
  v_pk_add_f32 v[38:39], v[38:39], v[214:215]
  v_pk_add_f32 v[40:41], v[40:41], v[216:217]
  v_pk_add_f32 v[42:43], v[42:43], v[218:219]
  v_pk_add_f32 v[44:45], v[44:45], v[220:221]
  v_pk_add_f32 v[46:47], v[46:47], v[222:223]
  v_pk_add_f32 v[48:49], v[48:49], v[224:225]
  v_pk_add_f32 v[50:51], v[50:51], v[226:227]
  v_pk_add_f32 v[52:53], v[52:53], v[228:229]
  v_pk_add_f32 v[54:55], v[54:55], v[230:231]
  v_pk_add_f32 v[56:57], v[56:57], v[232:233]
  v_pk_add_f32 v[58:59], v[58:59], v[234:235]
  v_pk_add_f32 v[60:61], v[60:61], v[236:237]
  v_pk_add_f32 v[62:63], v[62:63], v[238:239]
  s_branch L_o_t3
L_o_a1:
  v_pk_add_f32 v[16:17], v[16:17], v[128:129]
  v_pk_add_f32 v[18:19], v[18:19], v[130:131]
  v_pk_add_f32 v[20:21], v[20:21], v[132:133]
  v_pk_add_f32 v[22:23], v[22:23], v[134:135]
  v_pk_add_f32 v[24:25], v[24:25], v[136:137]
  v_pk_add_f32 v[26:27], v[26:27], v[138:139]
  v_pk_add_f32 v[28:29], v[28:29], v[140:141]
  v_pk_add_f32 v[30:31], v[30:31], v[142:143]
  v_pk_add_f32 v[32:33], v[32:33], v[144:145]
  v_pk_add_f32 v[34:35], v[34:35], v[146:147]
  v_pk_add_f32 v[36:37], v[36:37], v[148:149]
  v_pk_add_f32 v[38:39], v[38:39], v[150:151]
  v_pk_add_f32 v[40:41], v[40:41], v[152:153]
  v_pk_add_f32 v[42:43], v[42:43], v[154:155]
  v_pk_add_f32 v[44:45], v[44:45], v[156:157]
  v_pk_add_f32 v[46:47], v[46:47], v[158:159]
  v_pk_add_f32 v[48:49], v[48:49], v[160:161]
  v_pk_add_f32 v[50:51], v[50:51], v[162:163]
  v_pk_add_f32 v[52:53], v[52:53], v[164:165]
  v_pk_add_f32 v[54:55], v[54:55], v[166:167]
  v_pk_add_f32 v[56:57], v[56:57], v[168:169]
  v_pk_add_f32 v[58:59], v[58:59], v[170:171]
  v_pk_add_f32 v[60:61], v[60:61], v[172:173]
  v_pk_add_f32 v[62:63], v[62:63], v[174:175]
L_o_t3:
  s_and_b32 s66, s42, 4
  s_call_b64 s[88:89], F_red
  s_cmp_ge_u32 s3, 6
  s_cbranch_scc1 L_o_end
  s_mul_i32 s22, s68, 0x40000
  s_cmp_lg_u32 s66, 0
  s_cbranch_scc1 L_f_got
  s_mov_b32 s71, 0
L_fc19:
  s_andn2_b32 s20, 4, s42
  s_cbranch_scc0 L_fo20
  s_sleep 0
  s_call_b64 s[88:89], F_poll
  s_branch L_fc19
L_fo20:
  buffer_load_dwordx4 v[64:67], v5, s[12:15], s6 offen sc1
  buffer_load_dwordx4 v[68:71], v5, s[12:15], s6 offen offset:1024 sc1
  s_waitcnt vmcnt(0)
L_f_got:
  s_waitcnt vmcnt(1)
  v_lshlrev_b32 v13, 16, v64
  v_and_b32 v14, 0xffff0000, v64
  v_add_f32 v112, v112, v13
  v_add_f32 v113, v113, v14
  v_cvt_pk_bf16_f32 v72, v112, v113
  v_lshlrev_b32 v13, 16, v65
  v_and_b32 v14, 0xffff0000, v65
  v_add_f32 v114, v114, v13
  v_add_f32 v115, v115, v14
  v_cvt_pk_bf16_f32 v73, v114, v115
  v_lshlrev_b32 v13, 16, v66
  v_and_b32 v14, 0xffff0000, v66
  v_add_f32 v116, v116, v13
  v_add_f32 v117, v117, v14
  v_cvt_pk_bf16_f32 v74, v116, v117
  v_lshlrev_b32 v13, 16, v67
  v_and_b32 v14, 0xffff0000, v67
  v_add_f32 v118, v118, v13
  v_add_f32 v119, v119, v14
  v_cvt_pk_bf16_f32 v75, v118, v119
  v_permlane16_swap_b32 v72, v74
  s_nop 0
  v_permlane16_swap_b32 v73, v75
  buffer_store_dwordx4 v[72:75], v1, s[16:19], s69 offen
  s_cmp_eq_u32 s68, 0
  s_cbranch_scc1 L_f_ok
  s_waitcnt vmcnt(1)
L_f_ld:
  v_max3_u32 v13, v68, v69, v70
  v_max_u32 v13, v13, v71
  v_cmp_eq_u32 vcc, -1, v13
  s_cbranch_vccz L_f_ok
  buffer_load_dwordx4 v[68:71], v5, s[12:15], s6 offen offset:1024 sc1
  s_sub_u32 s22, s22, 1
  s_cmp_lg_u32 s22, 0
  s_waitcnt vmcnt(0)
  s_cbranch_scc1 L_f_ld
L_f_ok:
  v_lshlrev_b32 v13, 16, v68
  v_and_b32 v14, 0xffff0000, v68
  v_add_f32 v120, v120, v13
  v_add_f32 v121, v121, v14
  v_cvt_pk_bf16_f32 v76, v120, v121
  v_lshlrev_b32 v13, 16, v69
  v_and_b32 v14, 0xffff0000, v69
  v_add_f32 v122, v122, v13
  v_add_f32 v123, v123, v14
  v_cvt_pk_bf16_f32 v77, v122, v123
  v_lshlrev_b32 v13, 16, v70
  v_and_b32 v14, 0xffff0000, v70
  v_add_f32 v124, v124, v13
  v_add_f32 v125, v125, v14
  v_cvt_pk_bf16_f32 v78, v124, v125
  v_lshlrev_b32 v13, 16, v71
  v_and_b32 v14, 0xffff0000, v71
  v_add_f32 v126, v126, v13
  v_add_f32 v127, v127, v14
  v_cvt_pk_bf16_f32 v79, v126, v127
  v_permlane16_swap_b32 v76, v78
  s_nop 0
  v_permlane16_swap_b32 v77, v79
  buffer_store_dwordx4 v[76:79], v1, s[16:19], s70 offen
L_o_end:
L_fin:
L_end:
  s_endpgm
F_poll:
  s_add_u32 s71, s71, 1
  s_and_b32 s20, s71, 7
  s_cbranch_scc0 L_p_v
  s_load_dword s39, s[60:61], s36 glc
  s_load_dword s40, s[60:61], s37 glc
  s_load_dword s41, s[60:61], s38 glc
  s_waitcnt lgkmcnt(0)
  s_lshl1_add_u32 s42, s40, s39
  s_lshl2_add_u32 s42, s41, s42
  s_setpc_b64 s[88:89]
L_p_v:
  v_mov_b32 v10, s36
  v_writelane_b32 v10, s37, 1
  v_writelane_b32 v10, s38, 2
  buffer_load_dword v11, v10, s[12:15], 0 offen sc1
  s_waitcnt vmcnt(0)
  v_cmp_eq_u32 s[20:21], 1, v11
  s_and_b32 s42, s20, 7
  s_cmp_ge_u32 s71, 0x40000
  s_cselect_b32 s42, 7, s42
  s_setpc_b64 s[88:89]
F_prime:
  s_add_u32 s20, s33, s72
  buffer_load_dwordx4 v[64:67], v5, s[12:15], s20 offen offset:0 sc1
  buffer_load_dwordx4 v[68:71], v5, s[12:15], s20 offen offset:1024 sc1
  buffer_load_dwordx4 v[72:75], v5, s[12:15], s20 offen offset:2048 sc1
  s_add_u32 s20, s33, s73
  buffer_load_dwordx4 v[76:79], v5, s[12:15], s20 offen offset:0 sc1
  buffer_load_dwordx4 v[80:83], v5, s[12:15], s20 offen offset:1024 sc1
  buffer_load_dwordx4 v[84:87], v5, s[12:15], s20 offen offset:2048 sc1
  s_add_u32 s20, s33, s74
  buffer_load_dwordx4 v[88:91], v5, s[12:15], s20 offen offset:0 sc1
  buffer_load_dwordx4 v[92:95], v5, s[12:15], s20 offen offset:1024 sc1
  buffer_load_dwordx4 v[96:99], v5, s[12:15], s20 offen offset:2048 sc1
  s_add_u32 s20, s33, s75
  buffer_load_dwordx4 v[100:103], v5, s[12:15], s20 offen offset:0 sc1
  buffer_load_dwordx4 v[104:107], v5, s[12:15], s20 offen offset:1024 sc1
  buffer_load_dwordx4 v[108:111], v5, s[12:15], s20 offen offset:2048 sc1
  s_setpc_b64 s[88:89]
F_h0:
  s_waitcnt vmcnt(9)
  v_mfma_f32_16x16x32_bf16 v[16:19], v[128:131], v[64:67], v[16:19]
  v_mfma_f32_16x16x32_bf16 v[28:31], v[132:135], v[64:67], v[28:31]
  v_mfma_f32_16x16x32_bf16 v[40:43], v[136:139], v[64:67], v[40:43]
  v_mfma_f32_16x16x32_bf16 v[52:55], v[140:143], v[64:67], v[52:55]
  v_mfma_f32_16x16x32_bf16 v[20:23], v[128:131], v[68:71], v[20:23]
  v_mfma_f32_16x16x32_bf16 v[32:35], v[132:135], v[68:71], v[32:35]
  v_mfma_f32_16x16x32_bf16 v[44:47], v[136:139], v[68:71], v[44:47]
  v_mfma_f32_16x16x32_bf16 v[56:59], v[140:143], v[68:71], v[56:59]
  v_mfma_f32_16x16x32_bf16 v[24:27], v[128:131], v[72:75], v[24:27]
  v_mfma_f32_16x16x32_bf16 v[36:39], v[132:135], v[72:75], v[36:39]
  v_mfma_f32_16x16x32_bf16 v[48:51], v[136:139], v[72:75], v[48:51]
  v_mfma_f32_16x16x32_bf16 v[60:63], v[140:143], v[72:75], v[60:63]
  s_cbranch_vccz L_hn21
  s_add_u32 s20, s33, s72
  buffer_load_dwordx4 v[64:67], v5, s[12:15], s20 offen offset:0 sc1
  buffer_load_dwordx4 v[68:71], v5, s[12:15], s20 offen offset:1024 sc1
  buffer_load_dwordx4 v[72:75], v5, s[12:15], s20 offen offset:2048 sc1
  s_waitcnt vmcnt(9)
  s_branch L_hj22
L_hn21:
  s_waitcnt vmcnt(6)
L_hj22:
  v_mfma_f32_16x16x32_bf16 v[16:19], v[144:147], v[76:79], v[16:19]
  v_mfma_f32_16x16x32_bf16 v[28:31], v[148:151], v[76:79], v[28:31]
  v_mfma_f32_16x16x32_bf16 v[40:43], v[152:155], v[76:79], v[40:43]
  v_mfma_f32_16x16x32_bf16 v[52:55], v[156:159], v[76:79], v[52:55]
  v_mfma_f32_16x16x32_bf16 v[20:23], v[144:147], v[80:83], v[20:23]
  v_mfma_f32_16x16x32_bf16 v[32:35], v[148:151], v[80:83], v[32:35]
  v_mfma_f32_16x16x32_bf16 v[44:47], v[152:155], v[80:83], v[44:47]
  v_mfma_f32_16x16x32_bf16 v[56:59], v[156:159], v[80:83], v[56:59]
  v_mfma_f32_16x16x32_bf16 v[24:27], v[144:147], v[84:87], v[24:27]
  v_mfma_f32_16x16x32_bf16 v[36:39], v[148:151], v[84:87], v[36:39]
  v_mfma_f32_16x16x32_bf16 v[48:51], v[152:155], v[84:87], v[48:51]
  v_mfma_f32_16x16x32_bf16 v[60:63], v[156:159], v[84:87], v[60:63]
  s_cbranch_vccz L_hn23
  s_add_u32 s20, s33, s73
  buffer_load_dwordx4 v[76:79], v5, s[12:15], s20 offen offset:0 sc1
  buffer_load_dwordx4 v[80:83], v5, s[12:15], s20 offen offset:1024 sc1
  buffer_load_dwordx4 v[84:87], v5, s[12:15], s20 offen offset:2048 sc1
  s_waitcnt vmcnt(9)
  s_branch L_hj24
L_hn23:
  s_waitcnt vmcnt(3)
L_hj24:
  v_mfma_f32_16x16x32_bf16 v[16:19], v[160:163], v[88:91], v[16:19]
  v_mfma_f32_16x16x32_bf16 v[28:31], v[164:167], v[88:91], v[28:31]
  v_mfma_f32_16x16x32_bf16 v[40:43], v[168:171], v[88:91], v[40:43]
  v_mfma_f32_16x16x32_bf16 v[52:55], v[172:175], v[88:91], v[52:55]
  v_mfma_f32_16x16x32_bf16 v[20:23], v[160:163], v[92:95], v[20:23]
  v_mfma_f32_16x16x32_bf16 v[32:35], v[164:167], v[92:95], v[32:35]
  v_mfma_f32_16x16x32_bf16 v[44:47], v[168:171], v[92:95], v[44:47]
  v_mfma_f32_16x16x32_bf16 v[56:59], v[172:175], v[92:95], v[56:59]
  v_mfma_f32_16x16x32_bf16 v[24:27], v[160:163], v[96:99], v[24:27]
  v_mfma_f32_16x16x32_bf16 v[36:39], v[164:167], v[96:99], v[36:39]
  v_mfma_f32_16x16x32_bf16 v[48:51], v[168:171], v[96:99], v[48:51]
  v_mfma_f32_16x16x32_bf16 v[60:63], v[172:175], v[96:99], v[60:63]
  s_cbranch_vccz L_hn25
  s_add_u32 s20, s33, s74
  buffer_load_dwordx4 v[88:91], v5, s[12:15], s20 offen offset:0 sc1
  buffer_load_dwordx4 v[92:95], v5, s[12:15], s20 offen offset:1024 sc1
  buffer_load_dwordx4 v[96:99], v5, s[12:15], s20 offen offset:2048 sc1
  s_waitcnt vmcnt(9)
  s_branch L_hj26
L_hn25:
  s_waitcnt vmcnt(0)
L_hj26:
  v_mfma_f32_16x16x32_bf16 v[16:19], v[176:179], v[100:103], v[16:19]
  v_mfma_f32_16x16x32_bf16 v[28:31], v[180:183], v[100:103], v[28:31]
  v_mfma_f32_16x16x32_bf16 v[40:43], v[184:187], v[100:103], v[40:43]
  v_mfma_f32_16x16x32_bf16 v[52:55], v[188:191], v[100:103], v[52:55]
  v_mfma_f32_16x16x32_bf16 v[20:23], v[176:179], v[104:107], v[20:23]
  v_mfma_f32_16x16x32_bf16 v[32:35], v[180:183], v[104:107], v[32:35]
  v_mfma_f32_16x16x32_bf16 v[44:47], v[184:187], v[104:107], v[44:47]
  v_mfma_f32_16x16x32_bf16 v[56:59], v[188:191], v[104:107], v[56:59]
  v_mfma_f32_16x16x32_bf16 v[24:27], v[176:179], v[108:111], v[24:27]
  v_mfma_f32_16x16x32_bf16 v[36:39], v[180:183], v[108:111], v[36:39]
  v_mfma_f32_16x16x32_bf16 v[48:51], v[184:187], v[108:111], v[48:51]
  v_mfma_f32_16x16x32_bf16 v[60:63], v[188:191], v[108:111], v[60:63]
  s_cbranch_vccz L_hn27
  s_add_u32 s20, s33, s75
  buffer_load_dwordx4 v[100:103], v5, s[12:15], s20 offen offset:0 sc1
  buffer_load_dwordx4 v[104:107], v5, s[12:15], s20 offen offset:1024 sc1
  buffer_load_dwordx4 v[108:111], v5, s[12:15], s20 offen offset:2048 sc1
L_hn27:
  s_setpc_b64 s[88:89]
F_h1:
  s_waitcnt vmcnt(9)
  v_mfma_f32_16x16x32_bf16 v[16:19], v[192:195], v[64:67], v[16:19]
  v_mfma_f32_16x16x32_bf16 v[28:31], v[196:199], v[64:67], v[28:31]
  v_mfma_f32_16x16x32_bf16 v[40:43], v[200:203], v[64:67], v[40:43]
  v_mfma_f32_16x16x32_bf16 v[52:55], v[204:207], v[64:67], v[52:55]
  v_mfma_f32_16x16x32_bf16 v[20:23], v[192:195], v[68:71], v[20:23]
  v_mfma_f32_16x16x32_bf16 v[32:35], v[196:199], v[68:71], v[32:35]
  v_mfma_f32_16x16x32_bf16 v[44:47], v[200:203], v[68:71], v[44:47]
  v_mfma_f32_16x16x32_bf16 v[56:59], v[204:207], v[68:71], v[56:59]
  v_mfma_f32_16x16x32_bf16 v[24:27], v[192:195], v[72:75], v[24:27]
  v_mfma_f32_16x16x32_bf16 v[36:39], v[196:199], v[72:75], v[36:39]
  v_mfma_f32_16x16x32_bf16 v[48:51], v[200:203], v[72:75], v[48:51]
  v_mfma_f32_16x16x32_bf16 v[60:63], v[204:207], v[72:75], v[60:63]
  s_cbranch_vccz L_hn29
  s_add_u32 s20, s33, s72
  buffer_load_dwordx4 v[64:67], v5, s[12:15], s20 offen offset:0 sc1
  buffer_load_dwordx4 v[68:71], v5, s[12:15], s20 offen offset:1024 sc1
  buffer_load_dwordx4 v[72:75], v5, s[12:15], s20 offen offset:2048 sc1
  s_waitcnt vmcnt(9)
  s_branch L_hj30
L_hn29:
  s_waitcnt vmcnt(6)
L_hj30:
  v_mfma_f32_16x16x32_bf16 v[16:19], v[208:211], v[76:79], v[16:19]
  v_mfma_f32_16x16x32_bf16 v[28:31], v[212:215], v[76:79], v[28:31]
  v_mfma_f32_16x16x32_bf16 v[40:43], v[216:219], v[76:79], v[40:43]
  v_mfma_f32_16x16x32_bf16 v[52:55], v[220:223], v[76:79], v[52:55]
  v_mfma_f32_16x16x32_bf16 v[20:23], v[208:211], v[80:83], v[20:23]
  v_mfma_f32_16x16x32_bf16 v[32:35], v[212:215], v[80:83], v[32:35]
  v_mfma_f32_16x16x32_bf16 v[44:47], v[216:219], v[80:83], v[44:47]
  v_mfma_f32_16x16x32_bf16 v[56:59], v[220:223], v[80:83], v[56:59]
  v_mfma_f32_16x16x32_bf16 v[24:27], v[208:211], v[84:87], v[24:27]
  v_mfma_f32_16x16x32_bf16 v[36:39], v[212:215], v[84:87], v[36:39]
  v_mfma_f32_16x16x32_bf16 v[48:51], v[216:219], v[84:87], v[48:51]
  v_mfma_f32_16x16x32_bf16 v[60:63], v[220:223], v[84:87], v[60:63]
  s_cbranch_vccz L_hn31
  s_add_u32 s20, s33, s73
  buffer_load_dwordx4 v[76:79], v5, s[12:15], s20 offen offset:0 sc1
  buffer_load_dwordx4 v[80:83], v5, s[12:15], s20 offen offset:1024 sc1
  buffer_load_dwordx4 v[84:87], v5, s[12:15], s20 offen offset:2048 sc1
  s_waitcnt vmcnt(9)
  s_branch L_hj32
L_hn31:
  s_waitcnt vmcnt(3)
L_hj32:
  v_mfma_f32_16x16x32_bf16 v[16:19], v[224:227], v[88:91], v[16:19]
  v_mfma_f32_16x16x32_bf16 v[28:31], v[228:231], v[88:91], v[28:31]
  v_mfma_f32_16x16x32_bf16 v[40:43], v[232:235], v[88:91], v[40:43]
  v_mfma_f32_16x16x32_bf16 v[52:55], v[236:239], v[88:91], v[52:55]
  v_mfma_f32_16x16x32_bf16 v[20:23], v[224:227], v[92:95], v[20:23]
  v_mfma_f32_16x16x32_bf16 v[32:35], v[228:231], v[92:95], v[32:35]
  v_mfma_f32_16x16x32_bf16 v[44:47], v[232:235], v[92:95], v[44:47]
  v_mfma_f32_16x16x32_bf16 v[56:59], v[236:239], v[92:95], v[56:59]
  v_mfma_f32_16x16x32_bf16 v[24:27], v[224:227], v[96:99], v[24:27]
  v_mfma_f32_16x16x32_bf16 v[36:39], v[228:231], v[96:99], v[36:39]
  v_mfma_f32_16x16x32_bf16 v[48:51], v[232:235], v[96:99], v[48:51]
  v_mfma_f32_16x16x32_bf16 v[60:63], v[236:239], v[96:99], v[60:63]
  s_cbranch_vccz L_hn33
  s_add_u32 s20, s33, s74
  buffer_load_dwordx4 v[88:91], v5, s[12:15], s20 offen offset:0 sc1
  buffer_load_dwordx4 v[92:95], v5, s[12:15], s20 offen offset:1024 sc1
  buffer_load_dwordx4 v[96:99], v5, s[12:15], s20 offen offset:2048 sc1
  s_waitcnt vmcnt(9)
  s_branch L_hj34
L_hn33:
  s_waitcnt vmcnt(0)
L_hj34:
  v_mfma_f32_16x16x32_bf16 v[16:19], v[240:243], v[100:103], v[16:19]
  v_mfma_f32_16x16x32_bf16 v[28:31], v[244:247], v[100:103], v[28:31]
  v_mfma_f32_16x16x32_bf16 v[40:43], v[248:251], v[100:103], v[40:43]
  v_mfma_f32_16x16x32_bf16 v[52:55], v[252:255], v[100:103], v[52:55]
  v_mfma_f32_16x16x32_bf16 v[20:23], v[240:243], v[104:107], v[20:23]
  v_mfma_f32_16x16x32_bf16 v[32:35], v[244:247], v[104:107], v[32:35]
  v_mfma_f32_16x16x32_bf16 v[44:47], v[248:251], v[104:107], v[44:47]
  v_mfma_f32_16x16x32_bf16 v[56:59], v[252:255], v[104:107], v[56:59]
  v_mfma_f32_16x16x32_bf16 v[24:27], v[240:243], v[108:111], v[24:27]
  v_mfma_f32_16x16x32_bf16 v[36:39], v[244:247], v[108:111], v[36:39]
  v_mfma_f32_16x16x32_bf16 v[48:51], v[248:251], v[108:111], v[48:51]
  v_mfma_f32_16x16x32_bf16 v[60:63], v[252:255], v[108:111], v[60:63]
  s_cbranch_vccz L_hn35
  s_add_u32 s20, s33, s75
  buffer_load_dwordx4 v[100:103], v5, s[12:15], s20 offen offset:0 sc1
  buffer_load_dwordx4 v[104:107], v5, s[12:15], s20 offen offset:1024 sc1
  buffer_load_dwordx4 v[108:111], v5, s[12:15], s20 offen offset:2048 sc1
L_hn35:
  s_setpc_b64 s[88:89]
F_red:
  v_add_u32 v12, s79, v5
  s_cmp_ge_u32 s3, 3
  s_cselect_b32 s20, 0, 1
  s_xor_b32 s20, s20, s28
  s_and_b32 s68, s20, 1
  s_cselect_b32 s20, 32, 38
  s_add_u32 s20, s20, s67
  s_lshl_b32 s20, s20, 10
  ds_write_b128 v12, v[16:19] offset:0
  ds_write_b128 v12, v[28:31] offset:3072
  ds_write_b128 v12, v[40:43] offset:6144
  ds_write_b128 v12, v[52:55] offset:9216
  ds_write_b128 v12, v[20:23] offset:1024
  ds_write_b128 v12, v[32:35] offset:4096
  ds_write_b128 v12, v[44:47] offset:7168
  ds_write_b128 v12, v[56:59] offset:10240
  ds_write_b128 v12, v[24:27] offset:2048
  ds_write_b128 v12, v[36:39] offset:5120
  ds_write_b128 v12, v[48:51] offset:8192
  ds_write_b128 v12, v[60:63] offset:11264
  v_add_u32 v12, s20, v5
  v_add_u32 v13, 49152, v12
  s_cmp_ge_u32 s3, 6
  s_cselect_b32 s68, 0, s68
  s_waitcnt lgkmcnt(0)
  s_barrier
  s_cbranch_scc1 L_r_skip
  s_cmp_eq_u32 s66, 0
  s_cbranch_scc1 L_r_nl
  buffer_load_dwordx4 v[64:67], v5, s[12:15], s6 offen sc1
  buffer_load_dwordx4 v[68:71], v5, s[12:15], s6 offen offset:1024 sc1
L_r_nl:
  ds_read_b128 v[16:19], v12 offset:0
  ds_read_b128 v[20:23], v12 offset:3072
  ds_read_b128 v[24:27], v12 offset:12288
  ds_read_b128 v[28:31], v12 offset:15360
  ds_read_b128 v[32:35], v12 offset:24576
  ds_read_b128 v[36:39], v12 offset:27648
  ds_read_b128 v[40:43], v12 offset:36864
  ds_read_b128 v[44:47], v12 offset:39936
  ds_read_b128 v[48:51], v13 offset:0
  ds_read_b128 v[52:55], v13 offset:3072
  ds_read_b128 v[56:59], v13 offset:12288
  ds_read_b128 v[60:63], v13 offset:15360
  s_waitcnt lgkmcnt(8)
  v_add_f32 v16, v16, v24
  v_add_f32 v17, v17, v25
  v_add_f32 v18, v18, v26
  v_add_f32 v19, v19, v27
  v_add_f32 v20, v20, v28
  v_add_f32 v21, v21, v29
  v_add_f32 v22, v22, v30
  v_add_f32 v23, v23, v31
  ds_read_b128 v[24:27], v13 offset:24576
  ds_read_b128 v[28:31], v13 offset:27648
  s_waitcnt lgkmcnt(8)
  v_add_f32 v16, v16, v32
  v_add_f32 v17, v17, v33
  v_add_f32 v18, v18, v34
  v_add_f32 v19, v19, v35
  v_add_f32 v20, v20, v36
  v_add_f32 v21, v21, v37
  v_add_f32 v22, v22, v38
  v_add_f32 v23, v23, v39
  ds_read_b128 v[32:35], v13 offset:36864
  ds_read_b128 v[36:39], v13 offset:39936
  s_waitcnt lgkmcnt(8)
  v_add_f32 v16, v16, v40
  v_add_f32 v17, v17, v41
  v_add_f32 v18, v18, v42
  v_add_f32 v19, v19, v43
  v_add_f32 v20, v20, v44
  v_add_f32 v21, v21, v45
  v_add_f32 v22, v22, v46
  v_add_f32 v23, v23, v47
  s_waitcnt lgkmcnt(6)
  v_add_f32 v16, v16, v48
  v_add_f32 v17, v17, v49
  v_add_f32 v18, v18, v50
  v_add_f32 v19, v19, v51
  v_add_f32 v20, v20, v52
  v_add_f32 v21, v21, v53
  v_add_f32 v22, v22, v54
  v_add_f32 v23, v23, v55
  s_waitcnt lgkmcnt(4)
  v_add_f32 v16, v16, v56
  v_add_f32 v17, v17, v57
  v_add_f32 v18, v18, v58
  v_add_f32 v19, v19, v59
  v_add_f32 v20, v20, v60
  v_add_f32 v21, v21, v61
  v_add_f32 v22, v22, v62
  v_add_f32 v23, v23, v63
  s_waitcnt lgkmcnt(2)
  v_add_f32 v16, v16, v24
  v_add_f32 v17, v17, v25
  v_add_f32 v18, v18, v26
  v_add_f32 v19, v19, v27
  v_add_f32 v20, v20, v28
  v_add_f32 v21, v21, v29
  v_add_f32 v22, v22, v30
  v_add_f32 v23, v23, v31
  s_waitcnt lgkmcnt(0)
  v_add_f32 v16, v16, v32
  v_add_f32 v17, v17, v33
  v_add_f32 v18, v18, v34
  v_add_f32 v19, v19, v35
  v_add_f32 v20, v20, v36
  v_add_f32 v21, v21, v37
  v_add_f32 v22, v22, v38
  v_add_f32 v23, v23, v39
  s_cmp_ge_u32 s28, 2
  s_cbranch_scc1 L_r_b
  s_cmp_eq_u32 s68, 0
  s_cbranch_scc0 L_r_own
  v_cvt_pk_bf16_f32 v120, v16, v17
  v_cvt_pk_bf16_f32 v121, v18, v19
  v_cvt_pk_bf16_f32 v122, v20, v21
  v_cvt_pk_bf16_f32 v123, v22, v23
  s_branch L_r_skip
L_r_own:
  v_mov_b64 v[112:113], v[16:17]
  v_mov_b64 v[114:115], v[18:19]
  v_mov_b64 v[116:117], v[20:21]
  v_mov_b64 v[118:119], v[22:23]
  s_branch L_r_skip
L_r_b:
  v_cvt_pk_bf16_f32 v24, v16, v17
  v_cvt_pk_bf16_f32 v25, v18, v19
  v_cvt_pk_bf16_f32 v26, v20, v21
  v_cvt_pk_bf16_f32 v27, v22, v23
  s_cmp_eq_u32 s68, 0
  s_cbranch_scc1 L_r_snd
  s_cmp_eq_u32 s28, 3
  s_cbranch_scc1 L_r_keep
  v_mov_b32 v24, -1
  v_mov_b32 v25, -1
  v_mov_b32 v26, -1
  v_mov_b32 v27, -1
L_r_snd:
  s_cmp_eq_u32 s28, 3
  s_cbranch_scc1 L_r_s3
  s_load_dword s39, s[60:61], s36 glc
  s_load_dword s40, s[60:61], s37 glc
  s_load_dword s41, s[60:61], s38 glc
  buffer_store_dwordx4 v[120:123], v5, s[12:15], s4 offen sc1
L_r_s3:
  buffer_store_dwordx4 v[24:27], v5, s[12:15], s4 offen offset:1024 sc1
  s_cbranch_scc1 L_r_ret
  s_mov_b32 s34, s5
  s_barrier
  v_mov_b64 v[120:121], v[16:17]
  v_mov_b64 v[122:123], v[18:19]
  v_mov_b64 v[124:125], v[20:21]
  v_mov_b64 v[126:127], v[22:23]
  s_branch L_r_z
L_r_keep:
  v_mov_b64 v[120:121], v[16:17]
  v_mov_b64 v[122:123], v[18:19]
  v_mov_b64 v[124:125], v[20:21]
  v_mov_b64 v[126:127], v[22:23]
L_r_skip:
  s_cmp_eq_u32 s28, 3
  s_cbranch_scc1 L_r_ret
  s_mov_b32 s34, 0
  s_cmp_eq_u32 s28, 2
  s_cbranch_scc0 L_r_y
  s_load_dword s39, s[60:61], s36 glc
  s_load_dword s40, s[60:61], s37 glc
  s_load_dword s41, s[60:61], s38 glc
L_r_y:
  s_barrier
L_r_z:
  s_add_u32 s28, s28, 1
  v_mov_b64 v[16:17], 0
  v_mov_b64 v[18:19], 0
  v_mov_b64 v[20:21], 0
  v_mov_b64 v[22:23], 0
  v_mov_b64 v[24:25], 0
  v_mov_b64 v[26:27], 0
  v_mov_b64 v[28:29], 0
  v_mov_b64 v[30:31], 0
  v_mov_b64 v[32:33], 0
  v_mov_b64 v[34:35], 0
  v_mov_b64 v[36:37], 0
  v_mov_b64 v[38:39], 0
  v_mov_b64 v[40:41], 0
  v_mov_b64 v[42:43], 0
  v_mov_b64 v[44:45], 0
  v_mov_b64 v[46:47], 0
  v_mov_b64 v[48:49], 0
  v_mov_b64 v[50:51], 0
  v_mov_b64 v[52:53], 0
  v_mov_b64 v[54:55], 0
  v_mov_b64 v[56:57], 0
  v_mov_b64 v[58:59], 0
  v_mov_b64 v[60:61], 0
  v_mov_b64 v[62:63], 0
L_r_ret:
  s_setpc_b64 s[88:89]
F_rare:
  s_cmp_eq_u32 s70, 0
  s_cbranch_scc1 L_rare_go
  v_max3_f32 v252, v44, v45, v46
  v_max3_f32 v252, v47, v48, v252
  v_max3_f32 v252, v49, v50, v252
  v_max_f32 v252, v51, v252
  v_max3_f32 v253, v52, v53, v54
  v_max3_f32 v253, v55, v56, v253
  v_max3_f32 v253, v57, v58, v253
  v_max_f32 v253, v59, v253
  v_max3_f32 v254, v60, v61, v62
  v_max3_f32 v254, v63, v64, v254
  v_max3_f32 v254, v65, v66, v254
  v_max_f32 v254, v67, v254
  s_mov_b32 s69, 0x41800000
  v_max3_f32 v6, abs(v252), abs(v253), abs(v254)
  v_cmp_nge_f32 vcc, s69, v6
  s_cbranch_vccz L_rare_first
L_rare_go:
  s_mov_b32 s87, 1
  v_max3_f32 v5, v44, v45, v46
  v_max3_f32 v5, v47, v48, v5
  v_max3_f32 v5, v49, v50, v5
  v_max_f32 v5, v51, v5
  v_mov_b32 v6, v5
  s_nop 1
  v_permlane32_swap_b32 v6, v5
  v_max_f32 v5, v5, v6
  v_mov_b32 v6, v5
  s_nop 1
  v_permlane16_swap_b32 v6, v5
  v_max3_f32 v5, v5, v6, s70
  v_max_f32 v6, 0, v5
  v_exp_f32 v252, -v6
  v_sub_f32 v20, v20, v5
  v_sub_f32 v21, v21, v5
  v_sub_f32 v22, v22, v5
  v_sub_f32 v23, v23, v5
  v_sub_f32 v44, v44, v5
  v_sub_f32 v45, v45, v5
  v_sub_f32 v46, v46, v5
  v_sub_f32 v47, v47, v5
  v_sub_f32 v48, v48, v5
  v_sub_f32 v49, v49, v5
  v_sub_f32 v50, v50, v5
  v_sub_f32 v51, v51, v5
  v_max3_f32 v5, v52, v53, v54
  v_max3_f32 v5, v55, v56, v5
  v_max3_f32 v5, v57, v58, v5
  v_max_f32 v5, v59, v5
  v_mov_b32 v6, v5
  s_nop 1
  v_permlane32_swap_b32 v6, v5
  v_max_f32 v5, v5, v6
  v_mov_b32 v6, v5
  s_nop 1
  v_permlane16_swap_b32 v6, v5
  v_max3_f32 v5, v5, v6, s70
  v_max_f32 v6, 0, v5
  v_exp_f32 v253, -v6
  v_sub_f32 v24, v24, v5
  v_sub_f32 v25, v25, v5
  v_sub_f32 v26, v26, v5
  v_sub_f32 v27, v27, v5
  v_sub_f32 v52, v52, v5
  v_sub_f32 v53, v53, v5
  v_sub_f32 v54, v54, v5
  v_sub_f32 v55, v55, v5
  v_sub_f32 v56, v56, v5
  v_sub_f32 v57, v57, v5
  v_sub_f32 v58, v58, v5
  v_sub_f32 v59, v59, v5
  v_max3_f32 v5, v60, v61, v62
  v_max3_f32 v5, v63, v64, v5
  v_max3_f32 v5, v65, v66, v5
  v_max_f32 v5, v67, v5
  v_mov_b32 v6, v5
  s_nop 1
  v_permlane32_swap_b32 v6, v5
  v_max_f32 v5, v5, v6
  v_mov_b32 v6, v5
  s_nop 1
  v_permlane16_swap_b32 v6, v5
  v_max3_f32 v5, v5, v6, s70
  v_max_f32 v6, 0, v5
  v_exp_f32 v254, -v6
  v_sub_f32 v28, v28, v5
  v_sub_f32 v29, v29, v5
  v_sub_f32 v30, v30, v5
  v_sub_f32 v31, v31, v5
  v_sub_f32 v60, v60, v5
  v_sub_f32 v61, v61, v5
  v_sub_f32 v62, v62, v5
  v_sub_f32 v63, v63, v5
  v_sub_f32 v64, v64, v5
  v_sub_f32 v65, v65, v5
  v_sub_f32 v66, v66, v5
  v_sub_f32 v67, v67, v5
  s_cmp_eq_u32 s70, 0
  s_cbranch_scc0 L_rare_first
  v_mul_f32 v32, v32, v252
  v_mul_f32 v33, v33, v252
  v_mul_f32 v34, v34, v252
  v_mul_f32 v35, v35, v252
  v_mul_f32 v152, v152, v252
  v_mul_f32 v153, v153, v252
  v_mul_f32 v154, v154, v252
  v_mul_f32 v155, v155, v252
  v_mul_f32 v164, v164, v252
  v_mul_f32 v165, v165, v252
  v_mul_f32 v166, v166, v252
  v_mul_f32 v167, v167, v252
  v_mul_f32 v176, v176, v252
  v_mul_f32 v177, v177, v252
  v_mul_f32 v178, v178, v252
  v_mul_f32 v179, v179, v252
  v_mul_f32 v188, v188, v252
  v_mul_f32 v189, v189, v252
  v_mul_f32 v190, v190, v252
  v_mul_f32 v191, v191, v252
  v_mul_f32 v200, v200, v252
  v_mul_f32 v201, v201, v252
  v_mul_f32 v202, v202, v252
  v_mul_f32 v203, v203, v252
  v_mul_f32 v212, v212, v252
  v_mul_f32 v213, v213, v252
  v_mul_f32 v214, v214, v252
  v_mul_f32 v215, v215, v252
  v_mul_f32 v224, v224, v252
  v_mul_f32 v225, v225, v252
  v_mul_f32 v226, v226, v252
  v_mul_f32 v227, v227, v252
  v_mul_f32 v236, v236, v252
  v_mul_f32 v237, v237, v252
  v_mul_f32 v238, v238, v252
  v_mul_f32 v239, v239, v252
  v_mul_f32 v36, v36, v253
  v_mul_f32 v37, v37, v253
  v_mul_f32 v38, v38, v253
  v_mul_f32 v39, v39, v253
  v_mul_f32 v156, v156, v253
  v_mul_f32 v157, v157, v253
  v_mul_f32 v158, v158, v253
  v_mul_f32 v159, v159, v253
  v_mul_f32 v168, v168, v253
  v_mul_f32 v169, v169, v253
  v_mul_f32 v170, v170, v253
  v_mul_f32 v171, v171, v253
  v_mul_f32 v180, v180, v253
  v_mul_f32 v181, v181, v253
  v_mul_f32 v182, v182, v253
  v_mul_f32 v183, v183, v253
  v_mul_f32 v192, v192, v253
  v_mul_f32 v193, v193, v253
  v_mul_f32 v194, v194, v253
  v_mul_f32 v195, v195, v253
  v_mul_f32 v204, v204, v253
  v_mul_f32 v205, v205, v253
  v_mul_f32 v206, v206, v253
  v_mul_f32 v207, v207, v253
  v_mul_f32 v216, v216, v253
  v_mul_f32 v217, v217, v253
  v_mul_f32 v218, v218, v253
  v_mul_f32 v219, v219, v253
  v_mul_f32 v228, v228, v253
  v_mul_f32 v229, v229, v253
  v_mul_f32 v230, v230, v253
  v_mul_f32 v231, v231, v253
  v_mul_f32 v240, v240, v253
  v_mul_f32 v241, v241, v253
  v_mul_f32 v242, v242, v253
  v_mul_f32 v243, v243, v253
  v_mul_f32 v40, v40, v254
  v_mul_f32 v41, v41, v254
  v_mul_f32 v42, v42, v254
  v_mul_f32 v43, v43, v254
  v_mul_f32 v160, v160, v254
  v_mul_f32 v161, v161, v254
  v_mul_f32 v162, v162, v254
  v_mul_f32 v163, v163, v254
  v_mul_f32 v172, v172, v254
  v_mul_f32 v173, v173, v254
  v_mul_f32 v174, v174, v254
  v_mul_f32 v175, v175, v254
  v_mul_f32 v184, v184, v254
  v_mul_f32 v185, v185, v254
  v_mul_f32 v186, v186, v254
  v_mul_f32 v187, v187, v254
  v_mul_f32 v196, v196, v254
  v_mul_f32 v197, v197, v254
  v_mul_f32 v198, v198, v254
  v_mul_f32 v199, v199, v254
  v_mul_f32 v208, v208, v254
  v_mul_f32 v209, v209, v254
  v_mul_f32 v210, v210, v254
  v_mul_f32 v211, v211, v254
  v_mul_f32 v220, v220, v254
  v_mul_f32 v221, v221, v254
  v_mul_f32 v222, v222, v254
  v_mul_f32 v223, v223, v254
  v_mul_f32 v232, v232, v254
  v_mul_f32 v233, v233, v254
  v_mul_f32 v234, v234, v254
  v_mul_f32 v235, v235, v254
  v_mul_f32 v244, v244, v254
  v_mul_f32 v245, v245, v254
  v_mul_f32 v246, v246, v254
  v_mul_f32 v247, v247, v254
L_rare_first:
  s_mov_b32 s69, 0x41800000
  s_mov_b32 s70, 0
  s_setpc_b64 s[88:89]
F_last:
  v_lshlrev_b32 v125, 4, v0
  v_and_b32 v6, 15, v0
  v_add_u32 v117, s4, v125
  v_add_u32 v118, s5, v125
  v_add_u32 v119, s6, v125
  v_add_u32 v116, s7, v125
  v_lshl_add_u32 v120, v6, 5, s20
  v_mov_b32 v124, s21
  v_mov_b32 v132, s26
  v_mov_b32 v133, s87
  s_waitcnt lgkmcnt(14)
  v_mfma_f32_16x16x32_bf16 v[176:179], v[76:79], v[44:47], v[176:179]
  v_mov_b32 v21, v32
  v_mov_b32 v25, v36
  v_mfma_f32_16x16x32_bf16 v[180:183], v[76:79], v[52:55], v[180:183]
  v_mov_b32 v29, v40
  v_xor_b32 v121, 8, v120
  v_mfma_f32_16x16x32_bf16 v[184:187], v[76:79], v[60:63], v[184:187]
  v_xor_b32 v122, 16, v120
  v_xor_b32 v123, 24, v120
  s_waitcnt lgkmcnt(12)
  v_mfma_f32_16x16x32_bf16 v[188:191], v[80:83], v[44:47], v[188:191]
  v_lshrrev_b32 v5, 2, v6
  v_lshrrev_b32 v7, 4, v0
  v_mfma_f32_16x16x32_bf16 v[192:195], v[80:83], v[52:55], v[192:195]
  v_cmp_eq_u32 vcc, v5, v7
  v_and_b32 v5, 1, v0
  v_mfma_f32_16x16x32_bf16 v[196:199], v[80:83], v[60:63], v[196:199]
  v_lshlrev_b32 v5, 4, v5
  v_mov_b32 v7, 0x3f80
  s_waitcnt lgkmcnt(10)
  v_mfma_f32_16x16x32_bf16 v[200:203], v[84:87], v[44:47], v[200:203]
  v_lshlrev_b32 v5, v5, v7
  v_cndmask_b32 v5, 0, v5, vcc
  v_mfma_f32_16x16x32_bf16 v[204:207], v[84:87], v[52:55], v[204:207]
  v_and_b32 v7, 2, v0
  v_cmp_eq_u32 vcc, 0, v7
  v_mfma_f32_16x16x32_bf16 v[208:211], v[84:87], v[60:63], v[208:211]
  v_mov_b32 v126, 0
  v_mov_b32 v127, 0
  s_waitcnt lgkmcnt(8)
  v_mfma_f32_16x16x32_bf16 v[212:215], v[88:91], v[44:47], v[212:215]
  v_mov_b32 v130, 0
  v_mov_b32 v131, 0
  v_mfma_f32_16x16x32_bf16 v[216:219], v[88:91], v[52:55], v[216:219]
  v_cndmask_b32 v128, 0, v5, vcc
  v_sub_u32 v129, v5, v128
  v_mfma_f32_16x16x32_bf16 v[220:223], v[88:91], v[60:63], v[220:223]
  v_cvt_pk_bf16_f32 v176, v176, v177
  v_cvt_pk_bf16_f32 v177, v178, v179
  s_waitcnt lgkmcnt(0)
  v_mfma_f32_16x16x32_bf16 v[224:227], v[92:95], v[44:47], v[224:227]
  ds_write_b32 v132, v133 offset:3072
  v_cvt_pk_bf16_f32 v180, v180, v181
  v_cvt_pk_bf16_f32 v181, v182, v183
  v_mfma_f32_16x16x32_bf16 v[228:231], v[92:95], v[52:55], v[228:231]
  ds_write_b64 v120, v[20:21] offset:0
  v_cvt_pk_bf16_f32 v184, v184, v185
  v_cvt_pk_bf16_f32 v185, v186, v187
  v_mfma_f32_16x16x32_bf16 v[232:235], v[92:95], v[60:63], v[232:235]
  v_cvt_pk_bf16_f32 v178, v188, v189
  v_cvt_pk_bf16_f32 v179, v190, v191
  ds_write_b128 v117, v[176:179] offset:0
  v_mfma_f32_16x16x32_bf16 v[236:239], v[96:99], v[44:47], v[236:239]
  ds_write_b64 v120, v[24:25] offset:512
  v_cvt_pk_bf16_f32 v182, v192, v193
  v_cvt_pk_bf16_f32 v183, v194, v195
  ds_write_b128 v117, v[180:183] offset:1024
  v_mfma_f32_16x16x32_bf16 v[240:243], v[96:99], v[52:55], v[240:243]
  ds_write_b64 v120, v[28:29] offset:1024
  v_cvt_pk_bf16_f32 v186, v196, v197
  v_cvt_pk_bf16_f32 v187, v198, v199
  ds_write_b128 v117, v[184:187] offset:2048
  v_mfma_f32_16x16x32_bf16 v[244:247], v[96:99], v[60:63], v[244:247]
  v_cvt_pk_bf16_f32 v200, v200, v201
  v_cvt_pk_bf16_f32 v201, v202, v203
  v_mfma_f32_16x16x32_bf16 v[152:155], v[68:71], v[44:47], v[152:155]
  v_cvt_pk_bf16_f32 v204, v204, v205
  v_cvt_pk_bf16_f32 v205, v206, v207
  v_mfma_f32_16x16x32_bf16 v[156:159], v[68:71], v[52:55], v[156:159]
  v_cvt_pk_bf16_f32 v208, v208, v209
  v_cvt_pk_bf16_f32 v209, v210, v211
  v_mfma_f32_16x16x32_bf16 v[160:163], v[68:71], v[60:63], v[160:163]
  v_cvt_pk_bf16_f32 v202, v212, v213
  v_cvt_pk_bf16_f32 v203, v214, v215
  ds_write_b128 v118, v[200:203] offset:0
  v_mfma_f32_16x16x32_bf16 v[164:167], v[72:75], v[44:47], v[164:167]
  v_cvt_pk_bf16_f32 v206, v216, v217
  v_cvt_pk_bf16_f32 v207, v218, v219
  ds_write_b128 v118, v[204:207] offset:1024
  v_mfma_f32_16x16x32_bf16 v[168:171], v[72:75], v[52:55], v[168:171]
  v_cvt_pk_bf16_f32 v210, v220, v221
  v_cvt_pk_bf16_f32 v211, v222, v223
  ds_write_b128 v118, v[208:211] offset:2048
  v_mfma_f32_16x16x32_bf16 v[172:175], v[72:75], v[60:63], v[172:175]
  v_cvt_pk_bf16_f32 v224, v224, v225
  v_cvt_pk_bf16_f32 v225, v226, v227
  v_cvt_pk_bf16_f32 v228, v228, v229
  v_cvt_pk_bf16_f32 v229, v230, v231
  v_cvt_pk_bf16_f32 v232, v232, v233
  v_cvt_pk_bf16_f32 v233, v234, v235
  v_cvt_pk_bf16_f32 v226, v236, v237
  v_cvt_pk_bf16_f32 v227, v238, v239
  ds_write_b128 v119, v[224:227] offset:0
  v_cvt_pk_bf16_f32 v230, v240, v241
  v_cvt_pk_bf16_f32 v231, v242, v243
  ds_write_b128 v119, v[228:231] offset:1024
  v_cvt_pk_bf16_f32 v234, v244, v245
  v_cvt_pk_bf16_f32 v235, v246, v247
  ds_write_b128 v119, v[232:235] offset:2048
  s_waitcnt lgkmcnt(0)
  s_barrier
  ds_read_b128 v[16:19], v124 offset:3072
  ds_read_b128 v[176:179], v116 offset:0
  ds_read_b128 v[180:183], v116 offset:3072
  ds_read_b128 v[184:187], v116 offset:6144
  ds_read_b128 v[188:191], v116 offset:1024
  ds_read_b128 v[192:195], v116 offset:4096
  ds_read_b128 v[196:199], v116 offset:7168
  ds_read_b128 v[200:203], v116 offset:2048
  ds_read_b128 v[204:207], v116 offset:5120
  ds_read_b128 v[208:211], v116 offset:8192
  s_waitcnt lgkmcnt(9)
  v_or3_b32 v5, v16, v17, v18
  v_or_b32 v5, v5, v19
  v_cmp_ne_u32 vcc, 0, v5
  s_waitcnt lgkmcnt(6)
  ds_read_b64 v[44:45], v121 offset:0
  ds_read_b64 v[46:47], v122 offset:0
  ds_read_b64 v[48:49], v123 offset:0
  ds_read_b64 v[52:53], v121 offset:512
  ds_read_b64 v[54:55], v122 offset:512
  ds_read_b64 v[56:57], v123 offset:512
  ds_read_b64 v[60:61], v121 offset:1024
  ds_read_b64 v[62:63], v122 offset:1024
  ds_read_b64 v[64:65], v123 offset:1024
  s_cbranch_vccnz L_comb_gen
  v_mfma_f32_16x16x32_bf16 v[152:155], v[128:131], v[176:179], v[152:155]
  v_mfma_f32_16x16x32_bf16 v[164:167], v[126:129], v[176:179], v[164:167]
  v_mfma_f32_16x16x32_bf16 v[152:155], v[128:131], v[180:183], v[152:155]
  v_mfma_f32_16x16x32_bf16 v[164:167], v[126:129], v[180:183], v[164:167]
  v_mfma_f32_16x16x32_bf16 v[152:155], v[128:131], v[184:187], v[152:155]
  v_mfma_f32_16x16x32_bf16 v[164:167], v[126:129], v[184:187], v[164:167]
  s_waitcnt lgkmcnt(12)
  v_mfma_f32_16x16x32_bf16 v[156:159], v[128:131], v[188:191], v[156:159]
  v_mfma_f32_16x16x32_bf16 v[168:171], v[126:129], v[188:191], v[168:171]
  v_mfma_f32_16x16x32_bf16 v[156:159], v[128:131], v[192:195], v[156:159]
  v_mfma_f32_16x16x32_bf16 v[168:171], v[126:129], v[192:195], v[168:171]
  v_mfma_f32_16x16x32_bf16 v[156:159], v[128:131], v[196:199], v[156:159]
  v_mfma_f32_16x16x32_bf16 v[168:171], v[126:129], v[196:199], v[168:171]
  s_waitcnt lgkmcnt(9)
  v_mfma_f32_16x16x32_bf16 v[160:163], v[128:131], v[200:203], v[160:163]
  v_mfma_f32_16x16x32_bf16 v[172:175], v[126:129], v[200:203], v[172:175]
  v_mfma_f32_16x16x32_bf16 v[160:163], v[128:131], v[204:207], v[160:163]
  v_mfma_f32_16x16x32_bf16 v[172:175], v[126:129], v[204:207], v[172:175]
  v_mfma_f32_16x16x32_bf16 v[160:163], v[128:131], v[208:211], v[160:163]
  v_mfma_f32_16x16x32_bf16 v[172:175], v[126:129], v[208:211], v[172:175]
  s_waitcnt lgkmcnt(6)
  v_add_f32 v5, v45, v47
  v_add_f32 v6, v49, v21
  v_add_f32 v5, v5, v6
  v_rcp_f32 v68, v5
  s_waitcnt lgkmcnt(3)
  v_add_f32 v5, v53, v55
  v_add_f32 v6, v57, v25
  v_add_f32 v5, v5, v6
  v_rcp_f32 v69, v5
  s_waitcnt lgkmcnt(0)
  v_add_f32 v5, v61, v63
  v_add_f32 v6, v65, v29
  v_add_f32 v5, v5, v6
  v_rcp_f32 v70, v5
  v_mul_f32 v152, v152, v68
  v_mul_f32 v153, v153, v68
  v_mul_f32 v154, v154, v68
  v_mul_f32 v155, v155, v68
  v_mul_f32 v164, v164, v68
  v_mul_f32 v165, v165, v68
  v_mul_f32 v166, v166, v68
  v_mul_f32 v167, v167, v68
  v_cvt_pk_bf16_f32 v84, v152, v153
  v_cvt_pk_bf16_f32 v85, v154, v155
  v_cvt_pk_bf16_f32 v86, v164, v165
  v_cvt_pk_bf16_f32 v87, v166, v167
  buffer_store_dwordx4 v[84:87], v125, s[12:15], s27 offen offset:0 sc1
  v_mul_f32 v156, v156, v69
  v_mul_f32 v157, v157, v69
  v_mul_f32 v158, v158, v69
  v_mul_f32 v159, v159, v69
  v_mul_f32 v168, v168, v69
  v_mul_f32 v169, v169, v69
  v_mul_f32 v170, v170, v69
  v_mul_f32 v171, v171, v69
  v_cvt_pk_bf16_f32 v88, v156, v157
  v_cvt_pk_bf16_f32 v89, v158, v159
  v_cvt_pk_bf16_f32 v90, v168, v169
  v_cvt_pk_bf16_f32 v91, v170, v171
  buffer_store_dwordx4 v[88:91], v125, s[12:15], s27 offen offset:1024 sc1
  v_mul_f32 v160, v160, v70
  v_mul_f32 v161, v161, v70
  v_mul_f32 v162, v162, v70
  v_mul_f32 v163, v163, v70
  v_mul_f32 v172, v172, v70
  v_mul_f32 v173, v173, v70
  v_mul_f32 v174, v174, v70
  v_mul_f32 v175, v175, v70
  v_cvt_pk_bf16_f32 v92, v160, v161
  v_cvt_pk_bf16_f32 v93, v162, v163
  v_cvt_pk_bf16_f32 v94, v172, v173
  v_cvt_pk_bf16_f32 v95, v174, v175
  buffer_store_dwordx4 v[92:95], v125, s[12:15], s27 offen offset:2048 sc1
  s_setpc_b64 s[88:89]
L_comb_gen:
  s_waitcnt lgkmcnt(0)
  v_min3_f32 v5, v20, v44, v46
  v_min_f32 v5, v5, v48
  v_sub_f32 v68, v5, v20
  v_sub_f32 v69, v5, v44
  v_sub_f32 v70, v5, v46
  v_sub_f32 v71, v5, v48
  v_exp_f32 v68, v68
  v_exp_f32 v69, v69
  v_exp_f32 v70, v70
  v_exp_f32 v71, v71
  v_mul_f32 v6, v68, v21
  v_fmac_f32 v6, v69, v45
  v_fmac_f32 v6, v70, v47
  v_fmac_f32 v6, v71, v49
  v_rcp_f32 v6, v6
  s_nop 0
  v_mul_f32 v68, v68, v6
  v_mul_f32 v69, v69, v6
  v_mul_f32 v70, v70, v6
  v_mul_f32 v71, v71, v6
  v_min3_f32 v5, v24, v52, v54
  v_min_f32 v5, v5, v56
  v_sub_f32 v72, v5, v24
  v_sub_f32 v73, v5, v52
  v_sub_f32 v74, v5, v54
  v_sub_f32 v75, v5, v56
  v_exp_f32 v72, v72
  v_exp_f32 v73, v73
  v_exp_f32 v74, v74
  v_exp_f32 v75, v75
  v_mul_f32 v6, v72, v25
  v_fmac_f32 v6, v73, v53
  v_fmac_f32 v6, v74, v55
  v_fmac_f32 v6, v75, v57
  v_rcp_f32 v6, v6
  s_nop 0
  v_mul_f32 v72, v72, v6
  v_mul_f32 v73, v73, v6
  v_mul_f32 v74, v74, v6
  v_mul_f32 v75, v75, v6
  v_min3_f32 v5, v28, v60, v62
  v_min_f32 v5, v5, v64
  v_sub_f32 v76, v5, v28
  v_sub_f32 v77, v5, v60
  v_sub_f32 v78, v5, v62
  v_sub_f32 v79, v5, v64
  v_exp_f32 v76, v76
  v_exp_f32 v77, v77
  v_exp_f32 v78, v78
  v_exp_f32 v79, v79
  v_mul_f32 v6, v76, v29
  v_fmac_f32 v6, v77, v61
  v_fmac_f32 v6, v78, v63
  v_fmac_f32 v6, v79, v65
  v_rcp_f32 v6, v6
  s_nop 0
  v_mul_f32 v76, v76, v6
  v_mul_f32 v77, v77, v6
  v_mul_f32 v78, v78, v6
  v_mul_f32 v79, v79, v6
  v_mul_f32 v152, v152, v68
  v_mul_f32 v153, v153, v68
  v_mul_f32 v154, v154, v68
  v_mul_f32 v155, v155, v68
  v_mul_f32 v164, v164, v68
  v_mul_f32 v165, v165, v68
  v_mul_f32 v166, v166, v68
  v_mul_f32 v167, v167, v68
  v_lshlrev_b32 v5, 16, v176
  v_and_b32 v6, 0xffff0000, v176
  v_fmac_f32 v152, v5, v69
  v_fmac_f32 v153, v6, v69
  v_lshlrev_b32 v5, 16, v177
  v_and_b32 v6, 0xffff0000, v177
  v_fmac_f32 v154, v5, v69
  v_fmac_f32 v155, v6, v69
  v_lshlrev_b32 v5, 16, v178
  v_and_b32 v6, 0xffff0000, v178
  v_fmac_f32 v164, v5, v69
  v_fmac_f32 v165, v6, v69
  v_lshlrev_b32 v5, 16, v179
  v_and_b32 v6, 0xffff0000, v179
  v_fmac_f32 v166, v5, v69
  v_fmac_f32 v167, v6, v69
  v_lshlrev_b32 v5, 16, v180
  v_and_b32 v6, 0xffff0000, v180
  v_fmac_f32 v152, v5, v70
  v_fmac_f32 v153, v6, v70
  v_lshlrev_b32 v5, 16, v181
  v_and_b32 v6, 0xffff0000, v181
  v_fmac_f32 v154, v5, v70
  v_fmac_f32 v155, v6, v70
  v_lshlrev_b32 v5, 16, v182
  v_and_b32 v6, 0xffff0000, v182
  v_fmac_f32 v164, v5, v70
  v_fmac_f32 v165, v6, v70
  v_lshlrev_b32 v5, 16, v183
  v_and_b32 v6, 0xffff0000, v183
  v_fmac_f32 v166, v5, v70
  v_fmac_f32 v167, v6, v70
  v_lshlrev_b32 v5, 16, v184
  v_and_b32 v6, 0xffff0000, v184
  v_fmac_f32 v152, v5, v71
  v_fmac_f32 v153, v6, v71
  v_lshlrev_b32 v5, 16, v185
  v_and_b32 v6, 0xffff0000, v185
  v_fmac_f32 v154, v5, v71
  v_fmac_f32 v155, v6, v71
  v_lshlrev_b32 v5, 16, v186
  v_and_b32 v6, 0xffff0000, v186
  v_fmac_f32 v164, v5, v71
  v_fmac_f32 v165, v6, v71
  v_lshlrev_b32 v5, 16, v187
  v_and_b32 v6, 0xffff0000, v187
  v_fmac_f32 v166, v5, v71
  v_fmac_f32 v167, v6, v71
  v_cvt_pk_bf16_f32 v84, v152, v153
  v_cvt_pk_bf16_f32 v85, v154, v155
  v_cvt_pk_bf16_f32 v86, v164, v165
  v_cvt_pk_bf16_f32 v87, v166, v167
  buffer_store_dwordx4 v[84:87], v125, s[12:15], s27 offen offset:0 sc1
  v_mul_f32 v156, v156, v72
  v_mul_f32 v157, v157, v72
  v_mul_f32 v158, v158, v72
  v_mul_f32 v159, v159, v72
  v_mul_f32 v168, v168, v72
  v_mul_f32 v169, v169, v72
  v_mul_f32 v170, v170, v72
  v_mul_f32 v171, v171, v72
  v_lshlrev_b32 v5, 16, v188
  v_and_b32 v6, 0xffff0000, v188
  v_fmac_f32 v156, v5, v73
  v_fmac_f32 v157, v6, v73
  v_lshlrev_b32 v5, 16, v189
  v_and_b32 v6, 0xffff0000, v189
  v_fmac_f32 v158, v5, v73
  v_fmac_f32 v159, v6, v73
  v_lshlrev_b32 v5, 16, v190
  v_and_b32 v6, 0xffff0000, v190
  v_fmac_f32 v168, v5, v73
  v_fmac_f32 v169, v6, v73
  v_lshlrev_b32 v5, 16, v191
  v_and_b32 v6, 0xffff0000, v191
  v_fmac_f32 v170, v5, v73
  v_fmac_f32 v171, v6, v73
  v_lshlrev_b32 v5, 16, v192
  v_and_b32 v6, 0xffff0000, v192
  v_fmac_f32 v156, v5, v74
  v_fmac_f32 v157, v6, v74
  v_lshlrev_b32 v5, 16, v193
  v_and_b32 v6, 0xffff0000, v193
  v_fmac_f32 v158, v5, v74
  v_fmac_f32 v159, v6, v74
  v_lshlrev_b32 v5, 16, v194
  v_and_b32 v6, 0xffff0000, v194
  v_fmac_f32 v168, v5, v74
  v_fmac_f32 v169, v6, v74
  v_lshlrev_b32 v5, 16, v195
  v_and_b32 v6, 0xffff0000, v195
  v_fmac_f32 v170, v5, v74
  v_fmac_f32 v171, v6, v74
  v_lshlrev_b32 v5, 16, v196
  v_and_b32 v6, 0xffff0000, v196
  v_fmac_f32 v156, v5, v75
  v_fmac_f32 v157, v6, v75
  v_lshlrev_b32 v5, 16, v197
  v_and_b32 v6, 0xffff0000, v197
  v_fmac_f32 v158, v5, v75
  v_fmac_f32 v159, v6, v75
  v_lshlrev_b32 v5, 16, v198
  v_and_b32 v6, 0xffff0000, v198
  v_fmac_f32 v168, v5, v75
  v_fmac_f32 v169, v6, v75
  v_lshlrev_b32 v5, 16, v199
  v_and_b32 v6, 0xffff0000, v199
  v_fmac_f32 v170, v5, v75
  v_fmac_f32 v171, v6, v75
  v_cvt_pk_bf16_f32 v88, v156, v157
  v_cvt_pk_bf16_f32 v89, v158, v159
  v_cvt_pk_bf16_f32 v90, v168, v169
  v_cvt_pk_bf16_f32 v91, v170, v171
  buffer_store_dwordx4 v[88:91], v125, s[12:15], s27 offen offset:1024 sc1
  v_mul_f32 v160, v160, v76
  v_mul_f32 v161, v161, v76
  v_mul_f32 v162, v162, v76
  v_mul_f32 v163, v163, v76
  v_mul_f32 v172, v172, v76
  v_mul_f32 v173, v173, v76
  v_mul_f32 v174, v174, v76
  v_mul_f32 v175, v175, v76
  v_lshlrev_b32 v5, 16, v200
  v_and_b32 v6, 0xffff0000, v200
  v_fmac_f32 v160, v5, v77
  v_fmac_f32 v161, v6, v77
  v_lshlrev_b32 v5, 16, v201
  v_and_b32 v6, 0xffff0000, v201
  v_fmac_f32 v162, v5, v77
  v_fmac_f32 v163, v6, v77
  v_lshlrev_b32 v5, 16, v202
  v_and_b32 v6, 0xffff0000, v202
  v_fmac_f32 v172, v5, v77
  v_fmac_f32 v173, v6, v77
  v_lshlrev_b32 v5, 16, v203
  v_and_b32 v6, 0xffff0000, v203
  v_fmac_f32 v174, v5, v77
  v_fmac_f32 v175, v6, v77
  v_lshlrev_b32 v5, 16, v204
  v_and_b32 v6, 0xffff0000, v204
  v_fmac_f32 v160, v5, v78
  v_fmac_f32 v161, v6, v78
  v_lshlrev_b32 v5, 16, v205
  v_and_b32 v6, 0xffff0000, v205
  v_fmac_f32 v162, v5, v78
  v_fmac_f32 v163, v6, v78
  v_lshlrev_b32 v5, 16, v206
  v_and_b32 v6, 0xffff0000, v206
  v_fmac_f32 v172, v5, v78
  v_fmac_f32 v173, v6, v78
  v_lshlrev_b32 v5, 16, v207
  v_and_b32 v6, 0xffff0000, v207
  v_fmac_f32 v174, v5, v78
  v_fmac_f32 v175, v6, v78
  v_lshlrev_b32 v5, 16, v208
  v_and_b32 v6, 0xffff0000, v208
  v_fmac_f32 v160, v5, v79
  v_fmac_f32 v161, v6, v79
  v_lshlrev_b32 v5, 16, v209
  v_and_b32 v6, 0xffff0000, v209
  v_fmac_f32 v162, v5, v79
  v_fmac_f32 v163, v6, v79
  v_lshlrev_b32 v5, 16, v210
  v_and_b32 v6, 0xffff0000, v210
  v_fmac_f32 v172, v5, v79
  v_fmac_f32 v173, v6, v79
  v_lshlrev_b32 v5, 16, v211
  v_and_b32 v6, 0xffff0000, v211
  v_fmac_f32 v174, v5, v79
  v_fmac_f32 v175, v6, v79
  v_cvt_pk_bf16_f32 v92, v160, v161
  v_cvt_pk_bf16_f32 v93, v162, v163
  v_cvt_pk_bf16_f32 v94, v172, v173
  v_cvt_pk_bf16_f32 v95, v174, v175
  buffer_store_dwordx4 v[92:95], v125, s[12:15], s27 offen offset:2048 sc1
  s_setpc_b64 s[88:89]
L_code_end:
.section .rodata,"a"
.p2align 6
.amdhsa_kernel concat_heads__gqa_block_cached__mha_block_cached__near_ridge_kernel
  .amdhsa_next_free_vgpr 256
  .amdhsa_next_free_sgpr 102
  .amdhsa_accum_offset 256
  .amdhsa_group_segment_fixed_size 0
  .amdhsa_kernarg_size 104
  .amdhsa_user_sgpr_count 2
  .amdhsa_user_sgpr_kernarg_segment_ptr 1
  .amdhsa_system_sgpr_workgroup_id_x 1
.end_amdhsa_kernel
```
